```python
import torch

def _softmax(x, axis=-1):
    return torch.softmax(x, dim=axis)
def _gelu(x):
    return torch.nn.functional.gelu(x, approximate="tanh")
def _silu(x):
    return torch.nn.functional.silu(x)
def _sigmoid(x):
    return torch.sigmoid(x)
def _layernorm(x, axis=-1, eps=1e-5):
    m = x.mean(dim=axis, keepdim=True)
    v = x.var(dim=axis, keepdim=True, unbiased=False)
    return (x - m) / torch.sqrt(v + eps)
def _scatter_add(tgt, idx, src, axis=0):
    return tgt.clone().index_add_(axis, idx, src)
def _segment_sum(src, seg, n):
    out = torch.zeros((n,) + src.shape[1:], dtype=src.dtype)
    return out.index_add_(0, seg, src)
def _pad(x, pw):
    flat = tuple(v for pair in reversed(pw) for v in pair)
    return torch.nn.functional.pad(x, flat)

kernel_name = 'concat_heads__gqa_block_cached__gqa_block_cached__decode'

def setup_inputs():

    _w = (lambda a: (lambda t: t.to(torch.bfloat16) if t.is_floating_point() else t)(torch.as_tensor(a)))
    def _A_setup():
        B, Sq, D = 4, 1, 448
        Hq, Hkv, Sk, Dh = 16, 8, 8192, 256
        assert Hq % Hkv == 0, (Hq, Hkv)
        return {
            "x": _w((lambda *s: torch.randn(*s, dtype=torch.bfloat16) * 0.8)(B, Sq, D)),
            "k_cache": _w((lambda *s: torch.randn(*s, dtype=torch.bfloat16) * 0.8)(B, Hkv, Sk, Dh)),
            "v_cache": _w((lambda *s: torch.randn(*s, dtype=torch.bfloat16) * 0.05)(B, Hkv, Sk, Dh)),
            "wq": _w((lambda *s: torch.randn(*s, dtype=torch.bfloat16) * 0.8)(D, Hq * Dh) * (D ** -0.5)),
            "wo": _w((lambda *s: torch.randn(*s, dtype=torch.bfloat16) * 0.05)(Hq * Dh, D) * ((Hq * Dh) ** -0.5)),
        }
    _A_in = _A_setup()

    def _B_setup():
        B, Sq, D = 4, 1, 448
        Hq, Hkv, Sk, Dh = 16, 8, 8192, 256
        assert Hq % Hkv == 0, (Hq, Hkv)
        return {
            "x": _w((lambda *s: torch.randn(*s, dtype=torch.bfloat16) * 0.8)(B, Sq, D)),
            "k_cache": _w((lambda *s: torch.randn(*s, dtype=torch.bfloat16) * 0.8)(B, Hkv, Sk, Dh)),
            "v_cache": _w((lambda *s: torch.randn(*s, dtype=torch.bfloat16) * 0.05)(B, Hkv, Sk, Dh)),
            "wq": _w((lambda *s: torch.randn(*s, dtype=torch.bfloat16) * 0.8)(D, Hq * Dh) * (D ** -0.5)),
            "wo": _w((lambda *s: torch.randn(*s, dtype=torch.bfloat16) * 0.05)(Hq * Dh, D) * ((Hq * Dh) ** -0.5)),
        }
    _B_in = _B_setup()

    return {
        "A_x": _A_in["x"],
        "A_k_cache": _A_in["k_cache"],
        "A_v_cache": _A_in["v_cache"],
        "A_wq": _A_in["wq"],
        "A_wo": _A_in["wo"],
        "B_x": _B_in["x"],
        "B_k_cache": _B_in["k_cache"],
        "B_v_cache": _B_in["v_cache"],
        "B_wq": _B_in["wq"],
        "B_wo": _B_in["wo"],
    }

def reference(A_x, A_k_cache, A_v_cache, A_wq, A_wo, B_x, B_k_cache, B_v_cache, B_wq, B_wo):
    def _A_ref(x, k_cache, v_cache, wq, wo):
        B, Sq, D = x.shape
        Hq, Dh = 16, 256
        Hkv = k_cache.shape[1]
        rep = Hq // Hkv
        q = (lambda x, *d: x.permute(*d))((x @ wq).reshape(B, Sq, Hq, Dh), 0, 2, 1, 3)
        k = (lambda x, n, axis: torch.repeat_interleave(x, n, dim=axis))(k_cache, rep, axis=1)
        v = (lambda x, n, axis: torch.repeat_interleave(x, n, dim=axis))(v_cache, rep, axis=1)
        scores = torch.einsum("bhqd,bhkd->bhqk", q, k) * (Dh ** -0.5)
        p = _softmax(scores, axis=-1)
        o = torch.einsum("bhqk,bhkd->bhqd", p, v)
        return (lambda x, *d: x.permute(*d))(o, 0, 2, 1, 3).reshape(B, Sq, Hq * Dh) @ wo

    def _B_ref(x, k_cache, v_cache, wq, wo):
        B, Sq, D = x.shape
        Hq, Dh = 16, 256
        Hkv = k_cache.shape[1]
        rep = Hq // Hkv
        q = (lambda x, *d: x.permute(*d))((x @ wq).reshape(B, Sq, Hq, Dh), 0, 2, 1, 3)
        k = (lambda x, n, axis: torch.repeat_interleave(x, n, dim=axis))(k_cache, rep, axis=1)
        v = (lambda x, n, axis: torch.repeat_interleave(x, n, dim=axis))(v_cache, rep, axis=1)
        scores = torch.einsum("bhqd,bhkd->bhqk", q, k) * (Dh ** -0.5)
        p = _softmax(scores, axis=-1)
        o = torch.einsum("bhqk,bhkd->bhqd", p, v)
        return (lambda x, *d: x.permute(*d))(o, 0, 2, 1, 3).reshape(B, Sq, Hq * Dh) @ wo

    a = _A_ref(A_x, A_k_cache, A_v_cache, A_wq, A_wo)
    b = _B_ref(B_x, B_k_cache, B_v_cache, B_wq, B_wo)
    return torch.concatenate([a, b], axis=-1)
```

```asm
; @launch grid=(256,1,1) block=(320,1,1) lds=163840
.amdgcn_target "amdgcn-amd-amdhsa--gfx950"
  .text
  .globl concat_heads__gqa_block_cached__gqa_block_cached__decode_kernel
  .p2align 8
  .type concat_heads__gqa_block_cached__gqa_block_cached__decode_kernel,@function
concat_heads__gqa_block_cached__gqa_block_cached__decode_kernel:
  s_cmp_ge_u32 s2, 256
  s_cbranch_scc1 L_end_concat_heads__gqa_block_cached__gqa_block_cached__decode_kernel
  s_lshr_b32 s4, s2, 7
  s_mul_i32 s43, s4, 40
  s_add_u32 s46, s0, s43
  s_addc_u32 s47, s1, 0
  s_load_dwordx8 s[8:15], s[46:47], 0
  s_load_dwordx2 s[16:17], s[46:47], 32
  s_load_dwordx2 s[18:19], s[0:1], 80
  s_load_dwordx2 s[20:21], s[0:1], 96
  v_and_b32 v1, 63, v0
  v_lshrrev_b32 v20, 6, v0
  s_lshr_b32 s68, s2, 2
  s_and_b32 s5, s68, 31
  v_readfirstlane_b32 s3, v20
  s_and_b32 s6, s2, 3
  s_and_b32 s71, s2, 127
  s_lshr_b32 s69, s5, 3
  s_and_b32 s70, s5, 7
  s_lshl_b32 s7, s6, 2
  s_add_u32 s7, s7, s69
  s_mov_b32 s96, 0x3db8aa3b
  s_waitcnt lgkmcnt(0)
  s_lshl_b32 s43, s4, 8
  s_add_u32 s46, s20, s43
  s_addc_u32 s47, s21, 0
  s_load_dword s23, s[46:47], 0
  s_mov_b32 s36, s20
  s_mov_b32 s37, s21
  s_mov_b32 s38, 5767168
  s_mov_b32 s39, 0x20000
  s_cmp_eq_u32 s3, 4
  s_cbranch_scc1 L_cw_concat_heads__gqa_block_cached__gqa_block_cached__decode_kernel
  s_mov_b32 s32, s14
  s_mov_b32 s33, s15
  s_mov_b32 s34, 3670016
  s_mov_b32 s35, 0x20000
  v_lshrrev_b32 v20, 2, v1
  v_lshlrev_b32 v20, 13, v20
  v_and_b32 v21, 3, v1
  v_lshl_add_u32 v20, v21, 4, v20
  s_lshl_b32 s43, s70, 10
  s_lshl_b32 s44, s7, 6
  s_add_u32 s43, s43, s44
  s_mul_i32 s44, s3, 917504
  s_add_u32 s43, s43, s44
  s_mul_i32 s44, s3, 7168
  s_add_u32 s44, s44, 131072
  s_mov_b32 m0, s44
  s_add_u32 s44, s44, 1024
  buffer_load_dwordx4 v20, s[32:35], s43 offen nt lds
  s_add_u32 s43, s43, 131072
  s_mov_b32 m0, s44
  s_add_u32 s44, s44, 1024
  buffer_load_dwordx4 v20, s[32:35], s43 offen nt lds
  s_add_u32 s43, s43, 131072
  s_mov_b32 m0, s44
  s_add_u32 s44, s44, 1024
  buffer_load_dwordx4 v20, s[32:35], s43 offen nt lds
  s_add_u32 s43, s43, 131072
  s_mov_b32 m0, s44
  s_add_u32 s44, s44, 1024
  buffer_load_dwordx4 v20, s[32:35], s43 offen nt lds
  s_add_u32 s43, s43, 131072
  s_mov_b32 m0, s44
  s_add_u32 s44, s44, 1024
  buffer_load_dwordx4 v20, s[32:35], s43 offen nt lds
  s_add_u32 s43, s43, 131072
  s_mov_b32 m0, s44
  s_add_u32 s44, s44, 1024
  buffer_load_dwordx4 v20, s[32:35], s43 offen nt lds
  s_add_u32 s43, s43, 131072
  s_mov_b32 m0, s44
  s_add_u32 s44, s44, 1024
  buffer_load_dwordx4 v20, s[32:35], s43 offen nt lds
  s_add_u32 s43, s43, 131072
  s_lshl_b32 s43, s5, 22
  s_add_u32 s24, s10, s43
  s_addc_u32 s25, s11, 0
  s_mov_b32 s26, 4194304
  s_mov_b32 s27, 0x20000
  s_add_u32 s28, s12, s43
  s_addc_u32 s29, s13, 0
  s_mov_b32 s30, 4194304
  s_mov_b32 s31, 0x20000
  v_lshrrev_b32 v22, 5, v1
  v_and_b32 v23, 31, v1
  v_add_u32 v24, 0, v22
  v_lshlrev_b32 v24, 1, v24
  v_xor_b32 v24, v24, v23
  v_lshlrev_b32 v24, 4, v24
  v_lshl_add_u32 v2, v22, 9, v24
  v_add_u32 v24, 2, v22
  v_lshlrev_b32 v24, 1, v24
  v_xor_b32 v24, v24, v23
  v_lshlrev_b32 v24, 4, v24
  v_lshl_add_u32 v3, v22, 9, v24
  v_add_u32 v24, 4, v22
  v_lshlrev_b32 v24, 1, v24
  v_xor_b32 v24, v24, v23
  v_lshlrev_b32 v24, 4, v24
  v_lshl_add_u32 v4, v22, 9, v24
  v_add_u32 v24, 6, v22
  v_lshlrev_b32 v24, 1, v24
  v_xor_b32 v24, v24, v23
  v_lshlrev_b32 v24, 4, v24
  v_lshl_add_u32 v5, v22, 9, v24
  s_lshl_b32 s42, s3, 15
  s_lshl_b32 s64, s6, 7
  s_add_u32 s64, s64, s3
  s_lshl_b32 s64, s64, 13
  s_add_u32 s40, s64, 0
  s_add_u32 s41, s40, 4096
  s_add_u32 m0, s42, 0
  s_nop 0
  buffer_load_dwordx4 v2, s[24:27], s40 offen offset:0 nt lds
  buffer_load_dwordx4 v3, s[24:27], s40 offen offset:1024 nt lds
  buffer_load_dwordx4 v4, s[24:27], s40 offen offset:2048 nt lds
  buffer_load_dwordx4 v5, s[24:27], s40 offen offset:3072 nt lds
  s_add_u32 m0, s42, 4096
  s_nop 0
  buffer_load_dwordx4 v2, s[24:27], s41 offen offset:0 nt lds
  buffer_load_dwordx4 v3, s[24:27], s41 offen offset:1024 nt lds
  buffer_load_dwordx4 v4, s[24:27], s41 offen offset:2048 nt lds
  buffer_load_dwordx4 v5, s[24:27], s41 offen offset:3072 nt lds
  v_and_b32 v20, 15, v1
  v_lshrrev_b32 v21, 4, v1
  v_and_b32 v22, 1, v20
  v_lshlrev_b32 v22, 1, v22
  v_xor_b32 v22, v22, v21
  v_lshlrev_b32 v22, 4, v22
  v_bfe_u32 v23, v20, 1, 2
  v_lshlrev_b32 v23, 6, v23
  v_lshl_add_u32 v22, v20, 9, v22
  v_add_u32 v22, v22, v23
  v_xor_b32 v6, 0, v22
  v_add_u32 v6, s42, v6
  v_xor_b32 v7, 64, v22
  v_add_u32 v7, s42, v7
  v_xor_b32 v8, 128, v22
  v_add_u32 v8, s42, v8
  v_xor_b32 v9, 192, v22
  v_add_u32 v9, s42, v9
  v_lshrrev_b32 v22, 2, v20
  v_and_b32 v23, 3, v20
  v_lshl_add_u32 v22, v21, 2, v22
  v_and_b32 v24, 7, v22
  v_lshlrev_b32 v24, 5, v24
  v_lshl_add_u32 v24, v22, 9, v24
  v_lshl_add_u32 v24, v23, 3, v24
  v_xor_b32 v10, 0, v24
  v_add_u32 v10, s42, v10
  v_xor_b32 v11, 32, v24
  v_add_u32 v11, s42, v11
  v_xor_b32 v12, 64, v24
  v_add_u32 v12, s42, v12
  v_xor_b32 v13, 96, v24
  v_add_u32 v13, s42, v13
  v_xor_b32 v14, 128, v24
  v_add_u32 v14, s42, v14
  v_xor_b32 v15, 160, v24
  v_add_u32 v15, s42, v15
  v_xor_b32 v16, 192, v24
  v_add_u32 v16, s42, v16
  v_xor_b32 v17, 224, v24
  v_add_u32 v17, s42, v17
  s_mov_b32 s48, 0x30003
  s_mov_b32 s49, 0x30003
  s_mov_b32 s50, 0xc000c
  s_mov_b32 s51, 0xc000c
  s_mov_b32 s52, 0x300030
  s_mov_b32 s53, 0x300030
  s_mov_b32 s54, 0xc000c0
  s_mov_b32 s55, 0xc000c0
  s_mov_b32 s56, 0x3000300
  s_mov_b32 s57, 0x3000300
  s_mov_b32 s58, 0xc000c00
  s_mov_b32 s59, 0xc000c00
  s_mov_b32 s60, 0x30003000
  s_mov_b32 s61, 0x30003000
  s_mov_b32 s62, 0xc000c000
  s_mov_b32 s63, 0xc000c000
  v_mov_b32 v18, 0xf149f2ca
  v_mov_b32 v19, 0
  v_mov_b32 v36, 0
  v_mov_b32 v37, 0
  v_mov_b32 v38, 0
  v_mov_b32 v39, 0
  v_mov_b32 v40, 0
  v_mov_b32 v41, 0
  v_mov_b32 v42, 0
  v_mov_b32 v43, 0
  s_waitcnt vmcnt(8)
  s_barrier
  s_waitcnt vmcnt(0)
  s_add_u32 s40, s64, 32768
  s_add_u32 s41, s40, 4096
  s_add_u32 m0, s42, 8192
  s_nop 0
  buffer_load_dwordx4 v2, s[24:27], s40 offen offset:0 nt lds
  buffer_load_dwordx4 v3, s[24:27], s40 offen offset:1024 nt lds
  buffer_load_dwordx4 v4, s[24:27], s40 offen offset:2048 nt lds
  buffer_load_dwordx4 v5, s[24:27], s40 offen offset:3072 nt lds
  s_add_u32 m0, s42, 12288
  s_nop 0
  buffer_load_dwordx4 v2, s[24:27], s41 offen offset:0 nt lds
  buffer_load_dwordx4 v3, s[24:27], s41 offen offset:1024 nt lds
  buffer_load_dwordx4 v4, s[24:27], s41 offen offset:2048 nt lds
  buffer_load_dwordx4 v5, s[24:27], s41 offen offset:3072 nt lds
  s_waitcnt vmcnt(0)
  s_add_u32 s40, s64, 65536
  s_add_u32 s41, s40, 4096
  s_add_u32 m0, s42, 16384
  s_nop 0
  buffer_load_dwordx4 v2, s[24:27], s40 offen offset:0 nt lds
  buffer_load_dwordx4 v3, s[24:27], s40 offen offset:1024 nt lds
  buffer_load_dwordx4 v4, s[24:27], s40 offen offset:2048 nt lds
  buffer_load_dwordx4 v5, s[24:27], s40 offen offset:3072 nt lds
  s_add_u32 m0, s42, 20480
  s_nop 0
  buffer_load_dwordx4 v2, s[24:27], s41 offen offset:0 nt lds
  buffer_load_dwordx4 v3, s[24:27], s41 offen offset:1024 nt lds
  buffer_load_dwordx4 v4, s[24:27], s41 offen offset:2048 nt lds
  buffer_load_dwordx4 v5, s[24:27], s41 offen offset:3072 nt lds
  s_waitcnt vmcnt(0)
  s_add_u32 s40, s64, 98304
  s_add_u32 s41, s40, 4096
  s_add_u32 m0, s42, 24576
  s_nop 0
  buffer_load_dwordx4 v2, s[24:27], s40 offen offset:0 nt lds
  buffer_load_dwordx4 v3, s[24:27], s40 offen offset:1024 nt lds
  buffer_load_dwordx4 v4, s[24:27], s40 offen offset:2048 nt lds
  buffer_load_dwordx4 v5, s[24:27], s40 offen offset:3072 nt lds
  s_add_u32 m0, s42, 28672
  s_nop 0
  buffer_load_dwordx4 v2, s[24:27], s41 offen offset:0 nt lds
  buffer_load_dwordx4 v3, s[24:27], s41 offen offset:1024 nt lds
  buffer_load_dwordx4 v4, s[24:27], s41 offen offset:2048 nt lds
  buffer_load_dwordx4 v5, s[24:27], s41 offen offset:3072 nt lds
  s_waitcnt lgkmcnt(0)
  s_mul_i32 s22, s23, 0x9E3779B1
  s_add_u32 s22, s22, 0x7F4A7C15
  ds_read_b128 v[92:95], v6 offset:0
  ds_read_b128 v[96:99], v7 offset:0
  ds_read_b128 v[100:103], v8 offset:0
  ds_read_b128 v[104:107], v9 offset:0
  ds_read_b128 v[108:111], v6 offset:256
  ds_read_b128 v[112:115], v7 offset:256
  ds_read_b128 v[116:119], v8 offset:256
  ds_read_b128 v[120:123], v9 offset:256
  s_waitcnt lgkmcnt(0)
  s_waitcnt vmcnt(0)
  s_add_u32 s40, s64, 131072
  s_add_u32 s41, s40, 4096
  s_add_u32 m0, s42, 0
  s_nop 0
  buffer_load_dwordx4 v2, s[24:27], s40 offen offset:0 nt lds
  buffer_load_dwordx4 v3, s[24:27], s40 offen offset:1024 nt lds
  buffer_load_dwordx4 v4, s[24:27], s40 offen offset:2048 nt lds
  buffer_load_dwordx4 v5, s[24:27], s40 offen offset:3072 nt lds
  s_add_u32 m0, s42, 4096
  s_nop 0
  buffer_load_dwordx4 v2, s[24:27], s41 offen offset:0 nt lds
  buffer_load_dwordx4 v3, s[24:27], s41 offen offset:1024 nt lds
  buffer_load_dwordx4 v4, s[24:27], s41 offen offset:2048 nt lds
  buffer_load_dwordx4 v5, s[24:27], s41 offen offset:3072 nt lds
  ds_read_b128 v[220:223], v6 offset:8192
  ds_read_b128 v[224:227], v7 offset:8192
  ds_read_b128 v[228:231], v8 offset:8192
  ds_read_b128 v[232:235], v9 offset:8192
  ds_read_b128 v[236:239], v6 offset:8448
  ds_read_b128 v[240:243], v7 offset:8448
  ds_read_b128 v[244:247], v8 offset:8448
  ds_read_b128 v[248:251], v9 offset:8448
  s_waitcnt lgkmcnt(0)
  s_waitcnt vmcnt(0)
  s_add_u32 s40, s64, 163840
  s_add_u32 s41, s40, 4096
  s_add_u32 m0, s42, 8192
  s_nop 0
  buffer_load_dwordx4 v2, s[24:27], s40 offen offset:0 nt lds
  buffer_load_dwordx4 v3, s[24:27], s40 offen offset:1024 nt lds
  buffer_load_dwordx4 v4, s[24:27], s40 offen offset:2048 nt lds
  buffer_load_dwordx4 v5, s[24:27], s40 offen offset:3072 nt lds
  s_add_u32 m0, s42, 12288
  s_nop 0
  buffer_load_dwordx4 v2, s[24:27], s41 offen offset:0 nt lds
  buffer_load_dwordx4 v3, s[24:27], s41 offen offset:1024 nt lds
  buffer_load_dwordx4 v4, s[24:27], s41 offen offset:2048 nt lds
  buffer_load_dwordx4 v5, s[24:27], s41 offen offset:3072 nt lds
  v_mov_b32 v20, 160912
  s_mov_b32 s67, 0
Lq_concat_heads__gqa_block_cached__gqa_block_cached__decode_kernel_1:
  ds_read_b32 v21, v20
  s_waitcnt lgkmcnt(0)
  v_readfirstlane_b32 s43, v21
  s_add_u32 s67, s67, 1
  s_cmp_gt_u32 s67, 3200000
  s_cbranch_scc1 Lq_concat_heads__gqa_block_cached__gqa_block_cached__decode_kernel_1_x
  s_cmp_eq_u32 s43, 0
  s_cbranch_scc0 Lq_concat_heads__gqa_block_cached__gqa_block_cached__decode_kernel_1_x
  s_sleep 1
  s_branch Lq_concat_heads__gqa_block_cached__gqa_block_cached__decode_kernel_1
Lq_concat_heads__gqa_block_cached__gqa_block_cached__decode_kernel_1_x:
  v_and_b32 v20, 1, v1
  v_lshlrev_b32 v20, 9, v20
  v_lshrrev_b32 v21, 4, v1
  v_lshl_add_u32 v20, v21, 4, v20
  v_add_u32 v20, 159744, v20
  ds_read_b128 v[60:63], v20 offset:0
  ds_read_b128 v[64:67], v20 offset:64
  ds_read_b128 v[68:71], v20 offset:128
  ds_read_b128 v[72:75], v20 offset:192
  ds_read_b128 v[76:79], v20 offset:256
  ds_read_b128 v[80:83], v20 offset:320
  ds_read_b128 v[84:87], v20 offset:384
  ds_read_b128 v[88:91], v20 offset:448
  s_waitcnt lgkmcnt(0)
  v_mfma_f32_16x16x32_bf16 v[124:127], v[92:95], v[60:63], 0
  v_mfma_f32_16x16x32_bf16 v[124:127], v[96:99], v[64:67], v[124:127]
  v_mfma_f32_16x16x32_bf16 v[124:127], v[100:103], v[68:71], v[124:127]
  v_mfma_f32_16x16x32_bf16 v[124:127], v[104:107], v[72:75], v[124:127]
  v_mfma_f32_16x16x32_bf16 v[124:127], v[108:111], v[76:79], v[124:127]
  v_mfma_f32_16x16x32_bf16 v[124:127], v[112:115], v[80:83], v[124:127]
  v_mfma_f32_16x16x32_bf16 v[124:127], v[116:119], v[84:87], v[124:127]
  v_mfma_f32_16x16x32_bf16 v[124:127], v[120:123], v[88:91], v[124:127]
  v_mfma_f32_16x16x32_bf16 v[128:131], v[220:223], v[60:63], 0
  v_mfma_f32_16x16x32_bf16 v[128:131], v[224:227], v[64:67], v[128:131]
  v_mfma_f32_16x16x32_bf16 v[128:131], v[228:231], v[68:71], v[128:131]
  v_mfma_f32_16x16x32_bf16 v[128:131], v[232:235], v[72:75], v[128:131]
  v_mfma_f32_16x16x32_bf16 v[128:131], v[236:239], v[76:79], v[128:131]
  v_mfma_f32_16x16x32_bf16 v[128:131], v[240:243], v[80:83], v[128:131]
  v_mfma_f32_16x16x32_bf16 v[128:131], v[244:247], v[84:87], v[128:131]
  v_mfma_f32_16x16x32_bf16 v[128:131], v[248:251], v[88:91], v[128:131]
  s_nop 7
  v_cvt_pk_bf16_f32 v26, v124, v125
  v_lshlrev_b32 v124, 16, v26
  v_and_b32 v125, 0xffff0000, v26
  v_cvt_pk_bf16_f32 v27, v126, v127
  v_lshlrev_b32 v126, 16, v27
  v_and_b32 v127, 0xffff0000, v27
  v_max3_f32 v252, v124, v125, v126
  v_max_f32 v252, v252, v127
  s_add_u32 s40, s64, 196608
  s_add_u32 s41, s40, 4096
  ds_read_b128 v[92:95], v6 offset:16384
  ds_read_b128 v[96:99], v7 offset:16384
  ds_read_b128 v[100:103], v8 offset:16384
  ds_read_b128 v[104:107], v9 offset:16384
  ds_read_b128 v[108:111], v6 offset:16640
  ds_read_b128 v[112:115], v7 offset:16640
  ds_read_b128 v[116:119], v8 offset:16640
  ds_read_b128 v[120:123], v9 offset:16640
  v_cvt_pk_bf16_f32 v26, v128, v129
  v_lshlrev_b32 v128, 16, v26
  v_and_b32 v129, 0xffff0000, v26
  v_cvt_pk_bf16_f32 v27, v130, v131
  v_lshlrev_b32 v130, 16, v27
  v_and_b32 v131, 0xffff0000, v27
  v_max3_f32 v252, v252, v128, v129
  v_max3_f32 v252, v252, v130, v131
  s_waitcnt lgkmcnt(0)
  s_waitcnt vmcnt(0)
  s_add_u32 m0, s42, 16384
  s_nop 0
  buffer_load_dwordx4 v2, s[24:27], s40 offen offset:0 nt lds
  buffer_load_dwordx4 v3, s[24:27], s40 offen offset:1024 nt lds
  buffer_load_dwordx4 v4, s[24:27], s40 offen offset:2048 nt lds
  buffer_load_dwordx4 v5, s[24:27], s40 offen offset:3072 nt lds
  s_add_u32 m0, s42, 20480
  s_nop 0
  buffer_load_dwordx4 v2, s[24:27], s41 offen offset:0 nt lds
  buffer_load_dwordx4 v3, s[24:27], s41 offen offset:1024 nt lds
  buffer_load_dwordx4 v4, s[24:27], s41 offen offset:2048 nt lds
  buffer_load_dwordx4 v5, s[24:27], s41 offen offset:3072 nt lds
  v_mfma_f32_16x16x32_bf16 v[132:135], v[92:95], v[60:63], 0
  v_mfma_f32_16x16x32_bf16 v[132:135], v[96:99], v[64:67], v[132:135]
  v_mfma_f32_16x16x32_bf16 v[132:135], v[100:103], v[68:71], v[132:135]
  v_mfma_f32_16x16x32_bf16 v[132:135], v[104:107], v[72:75], v[132:135]
  v_mfma_f32_16x16x32_bf16 v[132:135], v[108:111], v[76:79], v[132:135]
  v_mfma_f32_16x16x32_bf16 v[132:135], v[112:115], v[80:83], v[132:135]
  v_mfma_f32_16x16x32_bf16 v[132:135], v[116:119], v[84:87], v[132:135]
  v_mfma_f32_16x16x32_bf16 v[132:135], v[120:123], v[88:91], v[132:135]
  s_add_u32 s40, s64, 229376
  s_add_u32 s41, s40, 4096
  ds_read_b128 v[92:95], v6 offset:24576
  ds_read_b128 v[96:99], v7 offset:24576
  ds_read_b128 v[100:103], v8 offset:24576
  ds_read_b128 v[104:107], v9 offset:24576
  ds_read_b128 v[108:111], v6 offset:24832
  ds_read_b128 v[112:115], v7 offset:24832
  ds_read_b128 v[116:119], v8 offset:24832
  ds_read_b128 v[120:123], v9 offset:24832
  v_cvt_pk_bf16_f32 v26, v132, v133
  v_lshlrev_b32 v132, 16, v26
  v_and_b32 v133, 0xffff0000, v26
  v_cvt_pk_bf16_f32 v27, v134, v135
  v_lshlrev_b32 v134, 16, v27
  v_and_b32 v135, 0xffff0000, v27
  v_max3_f32 v252, v252, v132, v133
  v_max3_f32 v252, v252, v134, v135
  s_waitcnt lgkmcnt(0)
  s_waitcnt vmcnt(0)
  s_add_u32 m0, s42, 24576
  s_nop 0
  buffer_load_dwordx4 v2, s[24:27], s40 offen offset:0 nt lds
  buffer_load_dwordx4 v3, s[24:27], s40 offen offset:1024 nt lds
  buffer_load_dwordx4 v4, s[24:27], s40 offen offset:2048 nt lds
  buffer_load_dwordx4 v5, s[24:27], s40 offen offset:3072 nt lds
  s_add_u32 m0, s42, 28672
  s_nop 0
  buffer_load_dwordx4 v2, s[24:27], s41 offen offset:0 nt lds
  buffer_load_dwordx4 v3, s[24:27], s41 offen offset:1024 nt lds
  buffer_load_dwordx4 v4, s[24:27], s41 offen offset:2048 nt lds
  buffer_load_dwordx4 v5, s[24:27], s41 offen offset:3072 nt lds
  v_mfma_f32_16x16x32_bf16 v[136:139], v[92:95], v[60:63], 0
  v_mfma_f32_16x16x32_bf16 v[136:139], v[96:99], v[64:67], v[136:139]
  v_mfma_f32_16x16x32_bf16 v[136:139], v[100:103], v[68:71], v[136:139]
  v_mfma_f32_16x16x32_bf16 v[136:139], v[104:107], v[72:75], v[136:139]
  v_mfma_f32_16x16x32_bf16 v[136:139], v[108:111], v[76:79], v[136:139]
  v_mfma_f32_16x16x32_bf16 v[136:139], v[112:115], v[80:83], v[136:139]
  v_mfma_f32_16x16x32_bf16 v[136:139], v[116:119], v[84:87], v[136:139]
  v_mfma_f32_16x16x32_bf16 v[136:139], v[120:123], v[88:91], v[136:139]
  s_add_u32 s40, s64, 262144
  s_add_u32 s41, s40, 4096
  ds_read_b128 v[92:95], v6 offset:0
  ds_read_b128 v[96:99], v7 offset:0
  ds_read_b128 v[100:103], v8 offset:0
  ds_read_b128 v[104:107], v9 offset:0
  ds_read_b128 v[108:111], v6 offset:256
  ds_read_b128 v[112:115], v7 offset:256
  ds_read_b128 v[116:119], v8 offset:256
  ds_read_b128 v[120:123], v9 offset:256
  v_cvt_pk_bf16_f32 v26, v136, v137
  v_lshlrev_b32 v136, 16, v26
  v_and_b32 v137, 0xffff0000, v26
  v_cvt_pk_bf16_f32 v27, v138, v139
  v_lshlrev_b32 v138, 16, v27
  v_and_b32 v139, 0xffff0000, v27
  v_max3_f32 v252, v252, v136, v137
  v_max3_f32 v252, v252, v138, v139
  s_waitcnt lgkmcnt(0)
  s_waitcnt vmcnt(0)
  s_add_u32 m0, s42, 0
  s_nop 0
  buffer_load_dwordx4 v2, s[24:27], s40 offen offset:0 nt lds
  buffer_load_dwordx4 v3, s[24:27], s40 offen offset:1024 nt lds
  buffer_load_dwordx4 v4, s[24:27], s40 offen offset:2048 nt lds
  buffer_load_dwordx4 v5, s[24:27], s40 offen offset:3072 nt lds
  s_add_u32 m0, s42, 4096
  s_nop 0
  buffer_load_dwordx4 v2, s[24:27], s41 offen offset:0 nt lds
  buffer_load_dwordx4 v3, s[24:27], s41 offen offset:1024 nt lds
  buffer_load_dwordx4 v4, s[24:27], s41 offen offset:2048 nt lds
  buffer_load_dwordx4 v5, s[24:27], s41 offen offset:3072 nt lds
  v_mfma_f32_16x16x32_bf16 v[140:143], v[92:95], v[60:63], 0
  v_mfma_f32_16x16x32_bf16 v[140:143], v[96:99], v[64:67], v[140:143]
  v_mfma_f32_16x16x32_bf16 v[140:143], v[100:103], v[68:71], v[140:143]
  v_mfma_f32_16x16x32_bf16 v[140:143], v[104:107], v[72:75], v[140:143]
  v_mfma_f32_16x16x32_bf16 v[140:143], v[108:111], v[76:79], v[140:143]
  v_mfma_f32_16x16x32_bf16 v[140:143], v[112:115], v[80:83], v[140:143]
  v_mfma_f32_16x16x32_bf16 v[140:143], v[116:119], v[84:87], v[140:143]
  v_mfma_f32_16x16x32_bf16 v[140:143], v[120:123], v[88:91], v[140:143]
  s_add_u32 s40, s64, 294912
  s_add_u32 s41, s40, 4096
  ds_read_b128 v[92:95], v6 offset:8192
  ds_read_b128 v[96:99], v7 offset:8192
  ds_read_b128 v[100:103], v8 offset:8192
  ds_read_b128 v[104:107], v9 offset:8192
  ds_read_b128 v[108:111], v6 offset:8448
  ds_read_b128 v[112:115], v7 offset:8448
  ds_read_b128 v[116:119], v8 offset:8448
  ds_read_b128 v[120:123], v9 offset:8448
  v_cvt_pk_bf16_f32 v26, v140, v141
  v_lshlrev_b32 v140, 16, v26
  v_and_b32 v141, 0xffff0000, v26
  v_cvt_pk_bf16_f32 v27, v142, v143
  v_lshlrev_b32 v142, 16, v27
  v_and_b32 v143, 0xffff0000, v27
  v_max3_f32 v252, v252, v140, v141
  v_max3_f32 v252, v252, v142, v143
  s_waitcnt lgkmcnt(0)
  s_waitcnt vmcnt(0)
  s_add_u32 m0, s42, 8192
  s_nop 0
  buffer_load_dwordx4 v2, s[24:27], s40 offen offset:0 nt lds
  buffer_load_dwordx4 v3, s[24:27], s40 offen offset:1024 nt lds
  buffer_load_dwordx4 v4, s[24:27], s40 offen offset:2048 nt lds
  buffer_load_dwordx4 v5, s[24:27], s40 offen offset:3072 nt lds
  s_add_u32 m0, s42, 12288
  s_nop 0
  buffer_load_dwordx4 v2, s[24:27], s41 offen offset:0 nt lds
  buffer_load_dwordx4 v3, s[24:27], s41 offen offset:1024 nt lds
  buffer_load_dwordx4 v4, s[24:27], s41 offen offset:2048 nt lds
  buffer_load_dwordx4 v5, s[24:27], s41 offen offset:3072 nt lds
  v_mfma_f32_16x16x32_bf16 v[144:147], v[92:95], v[60:63], 0
  v_mfma_f32_16x16x32_bf16 v[144:147], v[96:99], v[64:67], v[144:147]
  v_mfma_f32_16x16x32_bf16 v[144:147], v[100:103], v[68:71], v[144:147]
  v_mfma_f32_16x16x32_bf16 v[144:147], v[104:107], v[72:75], v[144:147]
  v_mfma_f32_16x16x32_bf16 v[144:147], v[108:111], v[76:79], v[144:147]
  v_mfma_f32_16x16x32_bf16 v[144:147], v[112:115], v[80:83], v[144:147]
  v_mfma_f32_16x16x32_bf16 v[144:147], v[116:119], v[84:87], v[144:147]
  v_mfma_f32_16x16x32_bf16 v[144:147], v[120:123], v[88:91], v[144:147]
  s_add_u32 s40, s64, 327680
  s_add_u32 s41, s40, 4096
  ds_read_b128 v[92:95], v6 offset:16384
  ds_read_b128 v[96:99], v7 offset:16384
  ds_read_b128 v[100:103], v8 offset:16384
  ds_read_b128 v[104:107], v9 offset:16384
  ds_read_b128 v[108:111], v6 offset:16640
  ds_read_b128 v[112:115], v7 offset:16640
  ds_read_b128 v[116:119], v8 offset:16640
  ds_read_b128 v[120:123], v9 offset:16640
  v_cvt_pk_bf16_f32 v26, v144, v145
  v_lshlrev_b32 v144, 16, v26
  v_and_b32 v145, 0xffff0000, v26
  v_cvt_pk_bf16_f32 v27, v146, v147
  v_lshlrev_b32 v146, 16, v27
  v_and_b32 v147, 0xffff0000, v27
  v_max3_f32 v252, v252, v144, v145
  v_max3_f32 v252, v252, v146, v147
  s_waitcnt lgkmcnt(0)
  s_waitcnt vmcnt(0)
  s_add_u32 m0, s42, 16384
  s_nop 0
  buffer_load_dwordx4 v2, s[24:27], s40 offen offset:0 nt lds
  buffer_load_dwordx4 v3, s[24:27], s40 offen offset:1024 nt lds
  buffer_load_dwordx4 v4, s[24:27], s40 offen offset:2048 nt lds
  buffer_load_dwordx4 v5, s[24:27], s40 offen offset:3072 nt lds
  s_add_u32 m0, s42, 20480
  s_nop 0
  buffer_load_dwordx4 v2, s[24:27], s41 offen offset:0 nt lds
  buffer_load_dwordx4 v3, s[24:27], s41 offen offset:1024 nt lds
  buffer_load_dwordx4 v4, s[24:27], s41 offen offset:2048 nt lds
  buffer_load_dwordx4 v5, s[24:27], s41 offen offset:3072 nt lds
  v_mfma_f32_16x16x32_bf16 v[148:151], v[92:95], v[60:63], 0
  v_mfma_f32_16x16x32_bf16 v[148:151], v[96:99], v[64:67], v[148:151]
  v_mfma_f32_16x16x32_bf16 v[148:151], v[100:103], v[68:71], v[148:151]
  v_mfma_f32_16x16x32_bf16 v[148:151], v[104:107], v[72:75], v[148:151]
  v_mfma_f32_16x16x32_bf16 v[148:151], v[108:111], v[76:79], v[148:151]
  v_mfma_f32_16x16x32_bf16 v[148:151], v[112:115], v[80:83], v[148:151]
  v_mfma_f32_16x16x32_bf16 v[148:151], v[116:119], v[84:87], v[148:151]
  v_mfma_f32_16x16x32_bf16 v[148:151], v[120:123], v[88:91], v[148:151]
  s_add_u32 s40, s64, 360448
  s_add_u32 s41, s40, 4096
  ds_read_b128 v[92:95], v6 offset:24576
  ds_read_b128 v[96:99], v7 offset:24576
  ds_read_b128 v[100:103], v8 offset:24576
  ds_read_b128 v[104:107], v9 offset:24576
  ds_read_b128 v[108:111], v6 offset:24832
  ds_read_b128 v[112:115], v7 offset:24832
  ds_read_b128 v[116:119], v8 offset:24832
  ds_read_b128 v[120:123], v9 offset:24832
  v_cvt_pk_bf16_f32 v26, v148, v149
  v_lshlrev_b32 v148, 16, v26
  v_and_b32 v149, 0xffff0000, v26
  v_cvt_pk_bf16_f32 v27, v150, v151
  v_lshlrev_b32 v150, 16, v27
  v_and_b32 v151, 0xffff0000, v27
  v_max3_f32 v252, v252, v148, v149
  v_max3_f32 v252, v252, v150, v151
  s_waitcnt lgkmcnt(0)
  s_waitcnt vmcnt(0)
  s_add_u32 m0, s42, 24576
  s_nop 0
  buffer_load_dwordx4 v2, s[24:27], s40 offen offset:0 nt lds
  buffer_load_dwordx4 v3, s[24:27], s40 offen offset:1024 nt lds
  buffer_load_dwordx4 v4, s[24:27], s40 offen offset:2048 nt lds
  buffer_load_dwordx4 v5, s[24:27], s40 offen offset:3072 nt lds
  s_add_u32 m0, s42, 28672
  s_nop 0
  buffer_load_dwordx4 v2, s[24:27], s41 offen offset:0 nt lds
  buffer_load_dwordx4 v3, s[24:27], s41 offen offset:1024 nt lds
  buffer_load_dwordx4 v4, s[24:27], s41 offen offset:2048 nt lds
  buffer_load_dwordx4 v5, s[24:27], s41 offen offset:3072 nt lds
  v_mfma_f32_16x16x32_bf16 v[152:155], v[92:95], v[60:63], 0
  v_mfma_f32_16x16x32_bf16 v[152:155], v[96:99], v[64:67], v[152:155]
  v_mfma_f32_16x16x32_bf16 v[152:155], v[100:103], v[68:71], v[152:155]
  v_mfma_f32_16x16x32_bf16 v[152:155], v[104:107], v[72:75], v[152:155]
  v_mfma_f32_16x16x32_bf16 v[152:155], v[108:111], v[76:79], v[152:155]
  v_mfma_f32_16x16x32_bf16 v[152:155], v[112:115], v[80:83], v[152:155]
  v_mfma_f32_16x16x32_bf16 v[152:155], v[116:119], v[84:87], v[152:155]
  v_mfma_f32_16x16x32_bf16 v[152:155], v[120:123], v[88:91], v[152:155]
  s_add_u32 s40, s64, 393216
  s_add_u32 s41, s40, 4096
  ds_read_b128 v[92:95], v6 offset:0
  ds_read_b128 v[96:99], v7 offset:0
  ds_read_b128 v[100:103], v8 offset:0
  ds_read_b128 v[104:107], v9 offset:0
  ds_read_b128 v[108:111], v6 offset:256
  ds_read_b128 v[112:115], v7 offset:256
  ds_read_b128 v[116:119], v8 offset:256
  ds_read_b128 v[120:123], v9 offset:256
  v_cvt_pk_bf16_f32 v26, v152, v153
  v_lshlrev_b32 v152, 16, v26
  v_and_b32 v153, 0xffff0000, v26
  v_cvt_pk_bf16_f32 v27, v154, v155
  v_lshlrev_b32 v154, 16, v27
  v_and_b32 v155, 0xffff0000, v27
  v_max3_f32 v252, v252, v152, v153
  v_max3_f32 v252, v252, v154, v155
  s_waitcnt lgkmcnt(0)
  s_waitcnt vmcnt(0)
  s_add_u32 m0, s42, 0
  s_nop 0
  buffer_load_dwordx4 v2, s[24:27], s40 offen offset:0 nt lds
  buffer_load_dwordx4 v3, s[24:27], s40 offen offset:1024 nt lds
  buffer_load_dwordx4 v4, s[24:27], s40 offen offset:2048 nt lds
  buffer_load_dwordx4 v5, s[24:27], s40 offen offset:3072 nt lds
  s_add_u32 m0, s42, 4096
  s_nop 0
  buffer_load_dwordx4 v2, s[24:27], s41 offen offset:0 nt lds
  buffer_load_dwordx4 v3, s[24:27], s41 offen offset:1024 nt lds
  buffer_load_dwordx4 v4, s[24:27], s41 offen offset:2048 nt lds
  buffer_load_dwordx4 v5, s[24:27], s41 offen offset:3072 nt lds
  v_mfma_f32_16x16x32_bf16 v[156:159], v[92:95], v[60:63], 0
  v_mfma_f32_16x16x32_bf16 v[156:159], v[96:99], v[64:67], v[156:159]
  v_mfma_f32_16x16x32_bf16 v[156:159], v[100:103], v[68:71], v[156:159]
  v_mfma_f32_16x16x32_bf16 v[156:159], v[104:107], v[72:75], v[156:159]
  v_mfma_f32_16x16x32_bf16 v[156:159], v[108:111], v[76:79], v[156:159]
  v_mfma_f32_16x16x32_bf16 v[156:159], v[112:115], v[80:83], v[156:159]
  v_mfma_f32_16x16x32_bf16 v[156:159], v[116:119], v[84:87], v[156:159]
  v_mfma_f32_16x16x32_bf16 v[156:159], v[120:123], v[88:91], v[156:159]
  s_add_u32 s40, s64, 425984
  s_add_u32 s41, s40, 4096
  ds_read_b128 v[92:95], v6 offset:8192
  ds_read_b128 v[96:99], v7 offset:8192
  ds_read_b128 v[100:103], v8 offset:8192
  ds_read_b128 v[104:107], v9 offset:8192
  ds_read_b128 v[108:111], v6 offset:8448
  ds_read_b128 v[112:115], v7 offset:8448
  ds_read_b128 v[116:119], v8 offset:8448
  ds_read_b128 v[120:123], v9 offset:8448
  v_cvt_pk_bf16_f32 v26, v156, v157
  v_lshlrev_b32 v156, 16, v26
  v_and_b32 v157, 0xffff0000, v26
  v_cvt_pk_bf16_f32 v27, v158, v159
  v_lshlrev_b32 v158, 16, v27
  v_and_b32 v159, 0xffff0000, v27
  v_max3_f32 v252, v252, v156, v157
  v_max3_f32 v252, v252, v158, v159
  s_waitcnt lgkmcnt(0)
  s_waitcnt vmcnt(0)
  s_add_u32 m0, s42, 8192
  s_nop 0
  buffer_load_dwordx4 v2, s[24:27], s40 offen offset:0 nt lds
  buffer_load_dwordx4 v3, s[24:27], s40 offen offset:1024 nt lds
  buffer_load_dwordx4 v4, s[24:27], s40 offen offset:2048 nt lds
  buffer_load_dwordx4 v5, s[24:27], s40 offen offset:3072 nt lds
  s_add_u32 m0, s42, 12288
  s_nop 0
  buffer_load_dwordx4 v2, s[24:27], s41 offen offset:0 nt lds
  buffer_load_dwordx4 v3, s[24:27], s41 offen offset:1024 nt lds
  buffer_load_dwordx4 v4, s[24:27], s41 offen offset:2048 nt lds
  buffer_load_dwordx4 v5, s[24:27], s41 offen offset:3072 nt lds
  v_mfma_f32_16x16x32_bf16 v[160:163], v[92:95], v[60:63], 0
  v_mfma_f32_16x16x32_bf16 v[160:163], v[96:99], v[64:67], v[160:163]
  v_mfma_f32_16x16x32_bf16 v[160:163], v[100:103], v[68:71], v[160:163]
  v_mfma_f32_16x16x32_bf16 v[160:163], v[104:107], v[72:75], v[160:163]
  v_mfma_f32_16x16x32_bf16 v[160:163], v[108:111], v[76:79], v[160:163]
  v_mfma_f32_16x16x32_bf16 v[160:163], v[112:115], v[80:83], v[160:163]
  v_mfma_f32_16x16x32_bf16 v[160:163], v[116:119], v[84:87], v[160:163]
  v_mfma_f32_16x16x32_bf16 v[160:163], v[120:123], v[88:91], v[160:163]
  s_add_u32 s40, s64, 458752
  s_add_u32 s41, s40, 4096
  ds_read_b128 v[92:95], v6 offset:16384
  ds_read_b128 v[96:99], v7 offset:16384
  ds_read_b128 v[100:103], v8 offset:16384
  ds_read_b128 v[104:107], v9 offset:16384
  ds_read_b128 v[108:111], v6 offset:16640
  ds_read_b128 v[112:115], v7 offset:16640
  ds_read_b128 v[116:119], v8 offset:16640
  ds_read_b128 v[120:123], v9 offset:16640
  v_cvt_pk_bf16_f32 v26, v160, v161
  v_lshlrev_b32 v160, 16, v26
  v_and_b32 v161, 0xffff0000, v26
  v_cvt_pk_bf16_f32 v27, v162, v163
  v_lshlrev_b32 v162, 16, v27
  v_and_b32 v163, 0xffff0000, v27
  v_max3_f32 v252, v252, v160, v161
  v_max3_f32 v252, v252, v162, v163
  s_waitcnt lgkmcnt(0)
  s_waitcnt vmcnt(0)
  s_add_u32 m0, s42, 16384
  s_nop 0
  buffer_load_dwordx4 v2, s[24:27], s40 offen offset:0 nt lds
  buffer_load_dwordx4 v3, s[24:27], s40 offen offset:1024 nt lds
  buffer_load_dwordx4 v4, s[24:27], s40 offen offset:2048 nt lds
  buffer_load_dwordx4 v5, s[24:27], s40 offen offset:3072 nt lds
  s_add_u32 m0, s42, 20480
  s_nop 0
  buffer_load_dwordx4 v2, s[24:27], s41 offen offset:0 nt lds
  buffer_load_dwordx4 v3, s[24:27], s41 offen offset:1024 nt lds
  buffer_load_dwordx4 v4, s[24:27], s41 offen offset:2048 nt lds
  buffer_load_dwordx4 v5, s[24:27], s41 offen offset:3072 nt lds
  v_mfma_f32_16x16x32_bf16 v[164:167], v[92:95], v[60:63], 0
  v_mfma_f32_16x16x32_bf16 v[164:167], v[96:99], v[64:67], v[164:167]
  v_mfma_f32_16x16x32_bf16 v[164:167], v[100:103], v[68:71], v[164:167]
  v_mfma_f32_16x16x32_bf16 v[164:167], v[104:107], v[72:75], v[164:167]
  v_mfma_f32_16x16x32_bf16 v[164:167], v[108:111], v[76:79], v[164:167]
  v_mfma_f32_16x16x32_bf16 v[164:167], v[112:115], v[80:83], v[164:167]
  v_mfma_f32_16x16x32_bf16 v[164:167], v[116:119], v[84:87], v[164:167]
  v_mfma_f32_16x16x32_bf16 v[164:167], v[120:123], v[88:91], v[164:167]
  s_add_u32 s40, s64, 491520
  s_add_u32 s41, s40, 4096
  ds_read_b128 v[92:95], v6 offset:24576
  ds_read_b128 v[96:99], v7 offset:24576
  ds_read_b128 v[100:103], v8 offset:24576
  ds_read_b128 v[104:107], v9 offset:24576
  ds_read_b128 v[108:111], v6 offset:24832
  ds_read_b128 v[112:115], v7 offset:24832
  ds_read_b128 v[116:119], v8 offset:24832
  ds_read_b128 v[120:123], v9 offset:24832
  v_cvt_pk_bf16_f32 v26, v164, v165
  v_lshlrev_b32 v164, 16, v26
  v_and_b32 v165, 0xffff0000, v26
  v_cvt_pk_bf16_f32 v27, v166, v167
  v_lshlrev_b32 v166, 16, v27
  v_and_b32 v167, 0xffff0000, v27
  v_max3_f32 v252, v252, v164, v165
  v_max3_f32 v252, v252, v166, v167
  s_waitcnt lgkmcnt(0)
  s_waitcnt vmcnt(0)
  s_add_u32 m0, s42, 24576
  s_nop 0
  buffer_load_dwordx4 v2, s[24:27], s40 offen offset:0 nt lds
  buffer_load_dwordx4 v3, s[24:27], s40 offen offset:1024 nt lds
  buffer_load_dwordx4 v4, s[24:27], s40 offen offset:2048 nt lds
  buffer_load_dwordx4 v5, s[24:27], s40 offen offset:3072 nt lds
  s_add_u32 m0, s42, 28672
  s_nop 0
  buffer_load_dwordx4 v2, s[24:27], s41 offen offset:0 nt lds
  buffer_load_dwordx4 v3, s[24:27], s41 offen offset:1024 nt lds
  buffer_load_dwordx4 v4, s[24:27], s41 offen offset:2048 nt lds
  buffer_load_dwordx4 v5, s[24:27], s41 offen offset:3072 nt lds
  v_mfma_f32_16x16x32_bf16 v[168:171], v[92:95], v[60:63], 0
  v_mfma_f32_16x16x32_bf16 v[168:171], v[96:99], v[64:67], v[168:171]
  v_mfma_f32_16x16x32_bf16 v[168:171], v[100:103], v[68:71], v[168:171]
  v_mfma_f32_16x16x32_bf16 v[168:171], v[104:107], v[72:75], v[168:171]
  v_mfma_f32_16x16x32_bf16 v[168:171], v[108:111], v[76:79], v[168:171]
  v_mfma_f32_16x16x32_bf16 v[168:171], v[112:115], v[80:83], v[168:171]
  v_mfma_f32_16x16x32_bf16 v[168:171], v[116:119], v[84:87], v[168:171]
  v_mfma_f32_16x16x32_bf16 v[168:171], v[120:123], v[88:91], v[168:171]
  s_add_u32 s40, s64, 524288
  s_add_u32 s41, s40, 4096
  ds_read_b128 v[92:95], v6 offset:0
  ds_read_b128 v[96:99], v7 offset:0
  ds_read_b128 v[100:103], v8 offset:0
  ds_read_b128 v[104:107], v9 offset:0
  ds_read_b128 v[108:111], v6 offset:256
  ds_read_b128 v[112:115], v7 offset:256
  ds_read_b128 v[116:119], v8 offset:256
  ds_read_b128 v[120:123], v9 offset:256
  v_cvt_pk_bf16_f32 v26, v168, v169
  v_lshlrev_b32 v168, 16, v26
  v_and_b32 v169, 0xffff0000, v26
  v_cvt_pk_bf16_f32 v27, v170, v171
  v_lshlrev_b32 v170, 16, v27
  v_and_b32 v171, 0xffff0000, v27
  v_max3_f32 v252, v252, v168, v169
  v_max3_f32 v252, v252, v170, v171
  s_waitcnt lgkmcnt(0)
  s_waitcnt vmcnt(0)
  s_add_u32 m0, s42, 0
  s_nop 0
  buffer_load_dwordx4 v2, s[24:27], s40 offen offset:0 nt lds
  buffer_load_dwordx4 v3, s[24:27], s40 offen offset:1024 nt lds
  buffer_load_dwordx4 v4, s[24:27], s40 offen offset:2048 nt lds
  buffer_load_dwordx4 v5, s[24:27], s40 offen offset:3072 nt lds
  s_add_u32 m0, s42, 4096
  s_nop 0
  buffer_load_dwordx4 v2, s[24:27], s41 offen offset:0 nt lds
  buffer_load_dwordx4 v3, s[24:27], s41 offen offset:1024 nt lds
  buffer_load_dwordx4 v4, s[24:27], s41 offen offset:2048 nt lds
  buffer_load_dwordx4 v5, s[24:27], s41 offen offset:3072 nt lds
  v_mfma_f32_16x16x32_bf16 v[172:175], v[92:95], v[60:63], 0
  v_mfma_f32_16x16x32_bf16 v[172:175], v[96:99], v[64:67], v[172:175]
  v_mfma_f32_16x16x32_bf16 v[172:175], v[100:103], v[68:71], v[172:175]
  v_mfma_f32_16x16x32_bf16 v[172:175], v[104:107], v[72:75], v[172:175]
  v_mfma_f32_16x16x32_bf16 v[172:175], v[108:111], v[76:79], v[172:175]
  v_mfma_f32_16x16x32_bf16 v[172:175], v[112:115], v[80:83], v[172:175]
  v_mfma_f32_16x16x32_bf16 v[172:175], v[116:119], v[84:87], v[172:175]
  v_mfma_f32_16x16x32_bf16 v[172:175], v[120:123], v[88:91], v[172:175]
  s_add_u32 s40, s64, 557056
  s_add_u32 s41, s40, 4096
  ds_read_b128 v[92:95], v6 offset:8192
  ds_read_b128 v[96:99], v7 offset:8192
  ds_read_b128 v[100:103], v8 offset:8192
  ds_read_b128 v[104:107], v9 offset:8192
  ds_read_b128 v[108:111], v6 offset:8448
  ds_read_b128 v[112:115], v7 offset:8448
  ds_read_b128 v[116:119], v8 offset:8448
  ds_read_b128 v[120:123], v9 offset:8448
  v_cvt_pk_bf16_f32 v26, v172, v173
  v_lshlrev_b32 v172, 16, v26
  v_and_b32 v173, 0xffff0000, v26
  v_cvt_pk_bf16_f32 v27, v174, v175
  v_lshlrev_b32 v174, 16, v27
  v_and_b32 v175, 0xffff0000, v27
  v_max3_f32 v252, v252, v172, v173
  v_max3_f32 v252, v252, v174, v175
  s_waitcnt lgkmcnt(0)
  s_waitcnt vmcnt(0)
  s_add_u32 m0, s42, 8192
  s_nop 0
  buffer_load_dwordx4 v2, s[24:27], s40 offen offset:0 nt lds
  buffer_load_dwordx4 v3, s[24:27], s40 offen offset:1024 nt lds
  buffer_load_dwordx4 v4, s[24:27], s40 offen offset:2048 nt lds
  buffer_load_dwordx4 v5, s[24:27], s40 offen offset:3072 nt lds
  s_add_u32 m0, s42, 12288
  s_nop 0
  buffer_load_dwordx4 v2, s[24:27], s41 offen offset:0 nt lds
  buffer_load_dwordx4 v3, s[24:27], s41 offen offset:1024 nt lds
  buffer_load_dwordx4 v4, s[24:27], s41 offen offset:2048 nt lds
  buffer_load_dwordx4 v5, s[24:27], s41 offen offset:3072 nt lds
  v_mfma_f32_16x16x32_bf16 v[176:179], v[92:95], v[60:63], 0
  v_mfma_f32_16x16x32_bf16 v[176:179], v[96:99], v[64:67], v[176:179]
  v_mfma_f32_16x16x32_bf16 v[176:179], v[100:103], v[68:71], v[176:179]
  v_mfma_f32_16x16x32_bf16 v[176:179], v[104:107], v[72:75], v[176:179]
  v_mfma_f32_16x16x32_bf16 v[176:179], v[108:111], v[76:79], v[176:179]
  v_mfma_f32_16x16x32_bf16 v[176:179], v[112:115], v[80:83], v[176:179]
  v_mfma_f32_16x16x32_bf16 v[176:179], v[116:119], v[84:87], v[176:179]
  v_mfma_f32_16x16x32_bf16 v[176:179], v[120:123], v[88:91], v[176:179]
  s_add_u32 s40, s64, 589824
  s_add_u32 s41, s40, 4096
  ds_read_b128 v[92:95], v6 offset:16384
  ds_read_b128 v[96:99], v7 offset:16384
  ds_read_b128 v[100:103], v8 offset:16384
  ds_read_b128 v[104:107], v9 offset:16384
  ds_read_b128 v[108:111], v6 offset:16640
  ds_read_b128 v[112:115], v7 offset:16640
  ds_read_b128 v[116:119], v8 offset:16640
  ds_read_b128 v[120:123], v9 offset:16640
  v_cvt_pk_bf16_f32 v26, v176, v177
  v_lshlrev_b32 v176, 16, v26
  v_and_b32 v177, 0xffff0000, v26
  v_cvt_pk_bf16_f32 v27, v178, v179
  v_lshlrev_b32 v178, 16, v27
  v_and_b32 v179, 0xffff0000, v27
  v_max3_f32 v252, v252, v176, v177
  v_max3_f32 v252, v252, v178, v179
  s_waitcnt lgkmcnt(0)
  s_waitcnt vmcnt(0)
  s_add_u32 m0, s42, 16384
  s_nop 0
  buffer_load_dwordx4 v2, s[24:27], s40 offen offset:0 nt lds
  buffer_load_dwordx4 v3, s[24:27], s40 offen offset:1024 nt lds
  buffer_load_dwordx4 v4, s[24:27], s40 offen offset:2048 nt lds
  buffer_load_dwordx4 v5, s[24:27], s40 offen offset:3072 nt lds
  s_add_u32 m0, s42, 20480
  s_nop 0
  buffer_load_dwordx4 v2, s[24:27], s41 offen offset:0 nt lds
  buffer_load_dwordx4 v3, s[24:27], s41 offen offset:1024 nt lds
  buffer_load_dwordx4 v4, s[24:27], s41 offen offset:2048 nt lds
  buffer_load_dwordx4 v5, s[24:27], s41 offen offset:3072 nt lds
  v_mfma_f32_16x16x32_bf16 v[180:183], v[92:95], v[60:63], 0
  v_mfma_f32_16x16x32_bf16 v[180:183], v[96:99], v[64:67], v[180:183]
  v_mfma_f32_16x16x32_bf16 v[180:183], v[100:103], v[68:71], v[180:183]
  v_mfma_f32_16x16x32_bf16 v[180:183], v[104:107], v[72:75], v[180:183]
  v_mfma_f32_16x16x32_bf16 v[180:183], v[108:111], v[76:79], v[180:183]
  v_mfma_f32_16x16x32_bf16 v[180:183], v[112:115], v[80:83], v[180:183]
  v_mfma_f32_16x16x32_bf16 v[180:183], v[116:119], v[84:87], v[180:183]
  v_mfma_f32_16x16x32_bf16 v[180:183], v[120:123], v[88:91], v[180:183]
  s_add_u32 s40, s64, 622592
  s_add_u32 s41, s40, 4096
  ds_read_b128 v[92:95], v6 offset:24576
  ds_read_b128 v[96:99], v7 offset:24576
  ds_read_b128 v[100:103], v8 offset:24576
  ds_read_b128 v[104:107], v9 offset:24576
  ds_read_b128 v[108:111], v6 offset:24832
  ds_read_b128 v[112:115], v7 offset:24832
  ds_read_b128 v[116:119], v8 offset:24832
  ds_read_b128 v[120:123], v9 offset:24832
  v_cvt_pk_bf16_f32 v26, v180, v181
  v_lshlrev_b32 v180, 16, v26
  v_and_b32 v181, 0xffff0000, v26
  v_cvt_pk_bf16_f32 v27, v182, v183
  v_lshlrev_b32 v182, 16, v27
  v_and_b32 v183, 0xffff0000, v27
  v_max3_f32 v252, v252, v180, v181
  v_max3_f32 v252, v252, v182, v183
  s_waitcnt lgkmcnt(0)
  s_waitcnt vmcnt(0)
  s_add_u32 m0, s42, 24576
  s_nop 0
  buffer_load_dwordx4 v2, s[24:27], s40 offen offset:0 nt lds
  buffer_load_dwordx4 v3, s[24:27], s40 offen offset:1024 nt lds
  buffer_load_dwordx4 v4, s[24:27], s40 offen offset:2048 nt lds
  buffer_load_dwordx4 v5, s[24:27], s40 offen offset:3072 nt lds
  s_add_u32 m0, s42, 28672
  s_nop 0
  buffer_load_dwordx4 v2, s[24:27], s41 offen offset:0 nt lds
  buffer_load_dwordx4 v3, s[24:27], s41 offen offset:1024 nt lds
  buffer_load_dwordx4 v4, s[24:27], s41 offen offset:2048 nt lds
  buffer_load_dwordx4 v5, s[24:27], s41 offen offset:3072 nt lds
  v_mfma_f32_16x16x32_bf16 v[184:187], v[92:95], v[60:63], 0
  v_mfma_f32_16x16x32_bf16 v[184:187], v[96:99], v[64:67], v[184:187]
  v_mfma_f32_16x16x32_bf16 v[184:187], v[100:103], v[68:71], v[184:187]
  v_mfma_f32_16x16x32_bf16 v[184:187], v[104:107], v[72:75], v[184:187]
  v_mfma_f32_16x16x32_bf16 v[184:187], v[108:111], v[76:79], v[184:187]
  v_mfma_f32_16x16x32_bf16 v[184:187], v[112:115], v[80:83], v[184:187]
  v_mfma_f32_16x16x32_bf16 v[184:187], v[116:119], v[84:87], v[184:187]
  v_mfma_f32_16x16x32_bf16 v[184:187], v[120:123], v[88:91], v[184:187]
  s_add_u32 s40, s64, 655360
  s_add_u32 s41, s40, 4096
  ds_read_b128 v[92:95], v6 offset:0
  ds_read_b128 v[96:99], v7 offset:0
  ds_read_b128 v[100:103], v8 offset:0
  ds_read_b128 v[104:107], v9 offset:0
  ds_read_b128 v[108:111], v6 offset:256
  ds_read_b128 v[112:115], v7 offset:256
  ds_read_b128 v[116:119], v8 offset:256
  ds_read_b128 v[120:123], v9 offset:256
  v_cvt_pk_bf16_f32 v26, v184, v185
  v_lshlrev_b32 v184, 16, v26
  v_and_b32 v185, 0xffff0000, v26
  v_cvt_pk_bf16_f32 v27, v186, v187
  v_lshlrev_b32 v186, 16, v27
  v_and_b32 v187, 0xffff0000, v27
  v_max3_f32 v252, v252, v184, v185
  v_max3_f32 v252, v252, v186, v187
  s_waitcnt lgkmcnt(0)
  s_waitcnt vmcnt(0)
  s_add_u32 m0, s42, 0
  s_nop 0
  buffer_load_dwordx4 v2, s[24:27], s40 offen offset:0 nt lds
  buffer_load_dwordx4 v3, s[24:27], s40 offen offset:1024 nt lds
  buffer_load_dwordx4 v4, s[24:27], s40 offen offset:2048 nt lds
  buffer_load_dwordx4 v5, s[24:27], s40 offen offset:3072 nt lds
  s_add_u32 m0, s42, 4096
  s_nop 0
  buffer_load_dwordx4 v2, s[24:27], s41 offen offset:0 nt lds
  buffer_load_dwordx4 v3, s[24:27], s41 offen offset:1024 nt lds
  buffer_load_dwordx4 v4, s[24:27], s41 offen offset:2048 nt lds
  buffer_load_dwordx4 v5, s[24:27], s41 offen offset:3072 nt lds
  v_mfma_f32_16x16x32_bf16 v[188:191], v[92:95], v[60:63], 0
  v_mfma_f32_16x16x32_bf16 v[188:191], v[96:99], v[64:67], v[188:191]
  v_mfma_f32_16x16x32_bf16 v[188:191], v[100:103], v[68:71], v[188:191]
  v_mfma_f32_16x16x32_bf16 v[188:191], v[104:107], v[72:75], v[188:191]
  v_mfma_f32_16x16x32_bf16 v[188:191], v[108:111], v[76:79], v[188:191]
  v_mfma_f32_16x16x32_bf16 v[188:191], v[112:115], v[80:83], v[188:191]
  v_mfma_f32_16x16x32_bf16 v[188:191], v[116:119], v[84:87], v[188:191]
  v_mfma_f32_16x16x32_bf16 v[188:191], v[120:123], v[88:91], v[188:191]
  s_add_u32 s40, s64, 688128
  s_add_u32 s41, s40, 4096
  ds_read_b128 v[92:95], v6 offset:8192
  ds_read_b128 v[96:99], v7 offset:8192
  ds_read_b128 v[100:103], v8 offset:8192
  ds_read_b128 v[104:107], v9 offset:8192
  ds_read_b128 v[108:111], v6 offset:8448
  ds_read_b128 v[112:115], v7 offset:8448
  ds_read_b128 v[116:119], v8 offset:8448
  ds_read_b128 v[120:123], v9 offset:8448
  v_cvt_pk_bf16_f32 v26, v188, v189
  v_lshlrev_b32 v188, 16, v26
  v_and_b32 v189, 0xffff0000, v26
  v_cvt_pk_bf16_f32 v27, v190, v191
  v_lshlrev_b32 v190, 16, v27
  v_and_b32 v191, 0xffff0000, v27
  v_max3_f32 v252, v252, v188, v189
  v_max3_f32 v252, v252, v190, v191
  s_waitcnt lgkmcnt(0)
  s_waitcnt vmcnt(0)
  s_add_u32 m0, s42, 8192
  s_nop 0
  buffer_load_dwordx4 v2, s[24:27], s40 offen offset:0 nt lds
  buffer_load_dwordx4 v3, s[24:27], s40 offen offset:1024 nt lds
  buffer_load_dwordx4 v4, s[24:27], s40 offen offset:2048 nt lds
  buffer_load_dwordx4 v5, s[24:27], s40 offen offset:3072 nt lds
  s_add_u32 m0, s42, 12288
  s_nop 0
  buffer_load_dwordx4 v2, s[24:27], s41 offen offset:0 nt lds
  buffer_load_dwordx4 v3, s[24:27], s41 offen offset:1024 nt lds
  buffer_load_dwordx4 v4, s[24:27], s41 offen offset:2048 nt lds
  buffer_load_dwordx4 v5, s[24:27], s41 offen offset:3072 nt lds
  v_mfma_f32_16x16x32_bf16 v[192:195], v[92:95], v[60:63], 0
  v_mfma_f32_16x16x32_bf16 v[192:195], v[96:99], v[64:67], v[192:195]
  v_mfma_f32_16x16x32_bf16 v[192:195], v[100:103], v[68:71], v[192:195]
  v_mfma_f32_16x16x32_bf16 v[192:195], v[104:107], v[72:75], v[192:195]
  v_mfma_f32_16x16x32_bf16 v[192:195], v[108:111], v[76:79], v[192:195]
  v_mfma_f32_16x16x32_bf16 v[192:195], v[112:115], v[80:83], v[192:195]
  v_mfma_f32_16x16x32_bf16 v[192:195], v[116:119], v[84:87], v[192:195]
  v_mfma_f32_16x16x32_bf16 v[192:195], v[120:123], v[88:91], v[192:195]
  s_add_u32 s40, s64, 720896
  s_add_u32 s41, s40, 4096
  ds_read_b128 v[92:95], v6 offset:16384
  ds_read_b128 v[96:99], v7 offset:16384
  ds_read_b128 v[100:103], v8 offset:16384
  ds_read_b128 v[104:107], v9 offset:16384
  ds_read_b128 v[108:111], v6 offset:16640
  ds_read_b128 v[112:115], v7 offset:16640
  ds_read_b128 v[116:119], v8 offset:16640
  ds_read_b128 v[120:123], v9 offset:16640
  v_cvt_pk_bf16_f32 v26, v192, v193
  v_lshlrev_b32 v192, 16, v26
  v_and_b32 v193, 0xffff0000, v26
  v_cvt_pk_bf16_f32 v27, v194, v195
  v_lshlrev_b32 v194, 16, v27
  v_and_b32 v195, 0xffff0000, v27
  v_max3_f32 v252, v252, v192, v193
  v_max3_f32 v252, v252, v194, v195
  s_waitcnt lgkmcnt(0)
  s_waitcnt vmcnt(0)
  s_add_u32 m0, s42, 16384
  s_nop 0
  buffer_load_dwordx4 v2, s[24:27], s40 offen offset:0 nt lds
  buffer_load_dwordx4 v3, s[24:27], s40 offen offset:1024 nt lds
  buffer_load_dwordx4 v4, s[24:27], s40 offen offset:2048 nt lds
  buffer_load_dwordx4 v5, s[24:27], s40 offen offset:3072 nt lds
  s_add_u32 m0, s42, 20480
  s_nop 0
  buffer_load_dwordx4 v2, s[24:27], s41 offen offset:0 nt lds
  buffer_load_dwordx4 v3, s[24:27], s41 offen offset:1024 nt lds
  buffer_load_dwordx4 v4, s[24:27], s41 offen offset:2048 nt lds
  buffer_load_dwordx4 v5, s[24:27], s41 offen offset:3072 nt lds
  v_mfma_f32_16x16x32_bf16 v[196:199], v[92:95], v[60:63], 0
  v_mfma_f32_16x16x32_bf16 v[196:199], v[96:99], v[64:67], v[196:199]
  v_mfma_f32_16x16x32_bf16 v[196:199], v[100:103], v[68:71], v[196:199]
  v_mfma_f32_16x16x32_bf16 v[196:199], v[104:107], v[72:75], v[196:199]
  v_mfma_f32_16x16x32_bf16 v[196:199], v[108:111], v[76:79], v[196:199]
  v_mfma_f32_16x16x32_bf16 v[196:199], v[112:115], v[80:83], v[196:199]
  v_mfma_f32_16x16x32_bf16 v[196:199], v[116:119], v[84:87], v[196:199]
  v_mfma_f32_16x16x32_bf16 v[196:199], v[120:123], v[88:91], v[196:199]
  s_add_u32 s40, s64, 753664
  s_add_u32 s41, s40, 4096
  ds_read_b128 v[92:95], v6 offset:24576
  ds_read_b128 v[96:99], v7 offset:24576
  ds_read_b128 v[100:103], v8 offset:24576
  ds_read_b128 v[104:107], v9 offset:24576
  ds_read_b128 v[108:111], v6 offset:24832
  ds_read_b128 v[112:115], v7 offset:24832
  ds_read_b128 v[116:119], v8 offset:24832
  ds_read_b128 v[120:123], v9 offset:24832
  v_cvt_pk_bf16_f32 v26, v196, v197
  v_lshlrev_b32 v196, 16, v26
  v_and_b32 v197, 0xffff0000, v26
  v_cvt_pk_bf16_f32 v27, v198, v199
  v_lshlrev_b32 v198, 16, v27
  v_and_b32 v199, 0xffff0000, v27
  v_max3_f32 v252, v252, v196, v197
  v_max3_f32 v252, v252, v198, v199
  s_waitcnt lgkmcnt(0)
  s_waitcnt vmcnt(0)
  s_add_u32 m0, s42, 24576
  s_nop 0
  buffer_load_dwordx4 v2, s[24:27], s40 offen offset:0 nt lds
  buffer_load_dwordx4 v3, s[24:27], s40 offen offset:1024 nt lds
  buffer_load_dwordx4 v4, s[24:27], s40 offen offset:2048 nt lds
  buffer_load_dwordx4 v5, s[24:27], s40 offen offset:3072 nt lds
  s_add_u32 m0, s42, 28672
  s_nop 0
  buffer_load_dwordx4 v2, s[24:27], s41 offen offset:0 nt lds
  buffer_load_dwordx4 v3, s[24:27], s41 offen offset:1024 nt lds
  buffer_load_dwordx4 v4, s[24:27], s41 offen offset:2048 nt lds
  buffer_load_dwordx4 v5, s[24:27], s41 offen offset:3072 nt lds
  v_mfma_f32_16x16x32_bf16 v[200:203], v[92:95], v[60:63], 0
  v_mfma_f32_16x16x32_bf16 v[200:203], v[96:99], v[64:67], v[200:203]
  v_mfma_f32_16x16x32_bf16 v[200:203], v[100:103], v[68:71], v[200:203]
  v_mfma_f32_16x16x32_bf16 v[200:203], v[104:107], v[72:75], v[200:203]
  v_mfma_f32_16x16x32_bf16 v[200:203], v[108:111], v[76:79], v[200:203]
  v_mfma_f32_16x16x32_bf16 v[200:203], v[112:115], v[80:83], v[200:203]
  v_mfma_f32_16x16x32_bf16 v[200:203], v[116:119], v[84:87], v[200:203]
  v_mfma_f32_16x16x32_bf16 v[200:203], v[120:123], v[88:91], v[200:203]
  s_add_u32 s40, s64, 0
  s_add_u32 s41, s40, 4096
  ds_read_b128 v[92:95], v6 offset:0
  ds_read_b128 v[96:99], v7 offset:0
  ds_read_b128 v[100:103], v8 offset:0
  ds_read_b128 v[104:107], v9 offset:0
  ds_read_b128 v[108:111], v6 offset:256
  ds_read_b128 v[112:115], v7 offset:256
  ds_read_b128 v[116:119], v8 offset:256
  ds_read_b128 v[120:123], v9 offset:256
  v_cvt_pk_bf16_f32 v26, v200, v201
  v_lshlrev_b32 v200, 16, v26
  v_and_b32 v201, 0xffff0000, v26
  v_cvt_pk_bf16_f32 v27, v202, v203
  v_lshlrev_b32 v202, 16, v27
  v_and_b32 v203, 0xffff0000, v27
  v_max3_f32 v252, v252, v200, v201
  v_max3_f32 v252, v252, v202, v203
  s_waitcnt lgkmcnt(0)
  s_waitcnt vmcnt(0)
  s_add_u32 m0, s42, 0
  s_nop 0
  buffer_load_dwordx4 v2, s[28:31], s40 offen offset:0 nt lds
  buffer_load_dwordx4 v3, s[28:31], s40 offen offset:1024 nt lds
  buffer_load_dwordx4 v4, s[28:31], s40 offen offset:2048 nt lds
  buffer_load_dwordx4 v5, s[28:31], s40 offen offset:3072 nt lds
  s_add_u32 m0, s42, 4096
  s_nop 0
  buffer_load_dwordx4 v2, s[28:31], s41 offen offset:0 nt lds
  buffer_load_dwordx4 v3, s[28:31], s41 offen offset:1024 nt lds
  buffer_load_dwordx4 v4, s[28:31], s41 offen offset:2048 nt lds
  buffer_load_dwordx4 v5, s[28:31], s41 offen offset:3072 nt lds
  v_mfma_f32_16x16x32_bf16 v[204:207], v[92:95], v[60:63], 0
  v_mfma_f32_16x16x32_bf16 v[204:207], v[96:99], v[64:67], v[204:207]
  v_mfma_f32_16x16x32_bf16 v[204:207], v[100:103], v[68:71], v[204:207]
  v_mfma_f32_16x16x32_bf16 v[204:207], v[104:107], v[72:75], v[204:207]
  v_mfma_f32_16x16x32_bf16 v[204:207], v[108:111], v[76:79], v[204:207]
  v_mfma_f32_16x16x32_bf16 v[204:207], v[112:115], v[80:83], v[204:207]
  v_mfma_f32_16x16x32_bf16 v[204:207], v[116:119], v[84:87], v[204:207]
  v_mfma_f32_16x16x32_bf16 v[204:207], v[120:123], v[88:91], v[204:207]
  s_add_u32 s40, s64, 32768
  s_add_u32 s41, s40, 4096
  ds_read_b128 v[92:95], v6 offset:8192
  ds_read_b128 v[96:99], v7 offset:8192
  ds_read_b128 v[100:103], v8 offset:8192
  ds_read_b128 v[104:107], v9 offset:8192
  ds_read_b128 v[108:111], v6 offset:8448
  ds_read_b128 v[112:115], v7 offset:8448
  ds_read_b128 v[116:119], v8 offset:8448
  ds_read_b128 v[120:123], v9 offset:8448
  v_cvt_pk_bf16_f32 v26, v204, v205
  v_lshlrev_b32 v204, 16, v26
  v_and_b32 v205, 0xffff0000, v26
  v_cvt_pk_bf16_f32 v27, v206, v207
  v_lshlrev_b32 v206, 16, v27
  v_and_b32 v207, 0xffff0000, v27
  v_max3_f32 v252, v252, v204, v205
  v_max3_f32 v252, v252, v206, v207
  s_waitcnt lgkmcnt(0)
  s_waitcnt vmcnt(0)
  s_add_u32 m0, s42, 8192
  s_nop 0
  buffer_load_dwordx4 v2, s[28:31], s40 offen offset:0 nt lds
  buffer_load_dwordx4 v3, s[28:31], s40 offen offset:1024 nt lds
  buffer_load_dwordx4 v4, s[28:31], s40 offen offset:2048 nt lds
  buffer_load_dwordx4 v5, s[28:31], s40 offen offset:3072 nt lds
  s_add_u32 m0, s42, 12288
  s_nop 0
  buffer_load_dwordx4 v2, s[28:31], s41 offen offset:0 nt lds
  buffer_load_dwordx4 v3, s[28:31], s41 offen offset:1024 nt lds
  buffer_load_dwordx4 v4, s[28:31], s41 offen offset:2048 nt lds
  buffer_load_dwordx4 v5, s[28:31], s41 offen offset:3072 nt lds
  v_mfma_f32_16x16x32_bf16 v[208:211], v[92:95], v[60:63], 0
  v_mfma_f32_16x16x32_bf16 v[208:211], v[96:99], v[64:67], v[208:211]
  v_mfma_f32_16x16x32_bf16 v[208:211], v[100:103], v[68:71], v[208:211]
  v_mfma_f32_16x16x32_bf16 v[208:211], v[104:107], v[72:75], v[208:211]
  v_mfma_f32_16x16x32_bf16 v[208:211], v[108:111], v[76:79], v[208:211]
  v_mfma_f32_16x16x32_bf16 v[208:211], v[112:115], v[80:83], v[208:211]
  v_mfma_f32_16x16x32_bf16 v[208:211], v[116:119], v[84:87], v[208:211]
  v_mfma_f32_16x16x32_bf16 v[208:211], v[120:123], v[88:91], v[208:211]
  s_add_u32 s40, s64, 65536
  s_add_u32 s41, s40, 4096
  ds_read_b128 v[92:95], v6 offset:16384
  ds_read_b128 v[96:99], v7 offset:16384
  ds_read_b128 v[100:103], v8 offset:16384
  ds_read_b128 v[104:107], v9 offset:16384
  ds_read_b128 v[108:111], v6 offset:16640
  ds_read_b128 v[112:115], v7 offset:16640
  ds_read_b128 v[116:119], v8 offset:16640
  ds_read_b128 v[120:123], v9 offset:16640
  v_cvt_pk_bf16_f32 v26, v208, v209
  v_lshlrev_b32 v208, 16, v26
  v_and_b32 v209, 0xffff0000, v26
  v_cvt_pk_bf16_f32 v27, v210, v211
  v_lshlrev_b32 v210, 16, v27
  v_and_b32 v211, 0xffff0000, v27
  v_max3_f32 v252, v252, v208, v209
  v_max3_f32 v252, v252, v210, v211
  s_waitcnt lgkmcnt(0)
  s_waitcnt vmcnt(0)
  s_add_u32 m0, s42, 16384
  s_nop 0
  buffer_load_dwordx4 v2, s[28:31], s40 offen offset:0 nt lds
  buffer_load_dwordx4 v3, s[28:31], s40 offen offset:1024 nt lds
  buffer_load_dwordx4 v4, s[28:31], s40 offen offset:2048 nt lds
  buffer_load_dwordx4 v5, s[28:31], s40 offen offset:3072 nt lds
  s_add_u32 m0, s42, 20480
  s_nop 0
  buffer_load_dwordx4 v2, s[28:31], s41 offen offset:0 nt lds
  buffer_load_dwordx4 v3, s[28:31], s41 offen offset:1024 nt lds
  buffer_load_dwordx4 v4, s[28:31], s41 offen offset:2048 nt lds
  buffer_load_dwordx4 v5, s[28:31], s41 offen offset:3072 nt lds
  v_mfma_f32_16x16x32_bf16 v[212:215], v[92:95], v[60:63], 0
  v_mfma_f32_16x16x32_bf16 v[212:215], v[96:99], v[64:67], v[212:215]
  v_mfma_f32_16x16x32_bf16 v[212:215], v[100:103], v[68:71], v[212:215]
  v_mfma_f32_16x16x32_bf16 v[212:215], v[104:107], v[72:75], v[212:215]
  v_mfma_f32_16x16x32_bf16 v[212:215], v[108:111], v[76:79], v[212:215]
  v_mfma_f32_16x16x32_bf16 v[212:215], v[112:115], v[80:83], v[212:215]
  v_mfma_f32_16x16x32_bf16 v[212:215], v[116:119], v[84:87], v[212:215]
  v_mfma_f32_16x16x32_bf16 v[212:215], v[120:123], v[88:91], v[212:215]
  s_add_u32 s40, s64, 98304
  s_add_u32 s41, s40, 4096
  ds_read_b128 v[92:95], v6 offset:24576
  ds_read_b128 v[96:99], v7 offset:24576
  ds_read_b128 v[100:103], v8 offset:24576
  ds_read_b128 v[104:107], v9 offset:24576
  ds_read_b128 v[108:111], v6 offset:24832
  ds_read_b128 v[112:115], v7 offset:24832
  ds_read_b128 v[116:119], v8 offset:24832
  ds_read_b128 v[120:123], v9 offset:24832
  v_cvt_pk_bf16_f32 v26, v212, v213
  v_lshlrev_b32 v212, 16, v26
  v_and_b32 v213, 0xffff0000, v26
  v_cvt_pk_bf16_f32 v27, v214, v215
  v_lshlrev_b32 v214, 16, v27
  v_and_b32 v215, 0xffff0000, v27
  v_max3_f32 v252, v252, v212, v213
  v_max3_f32 v252, v252, v214, v215
  s_waitcnt lgkmcnt(0)
  s_waitcnt vmcnt(0)
  s_add_u32 m0, s42, 24576
  s_nop 0
  buffer_load_dwordx4 v2, s[28:31], s40 offen offset:0 nt lds
  buffer_load_dwordx4 v3, s[28:31], s40 offen offset:1024 nt lds
  buffer_load_dwordx4 v4, s[28:31], s40 offen offset:2048 nt lds
  buffer_load_dwordx4 v5, s[28:31], s40 offen offset:3072 nt lds
  s_add_u32 m0, s42, 28672
  s_nop 0
  buffer_load_dwordx4 v2, s[28:31], s41 offen offset:0 nt lds
  buffer_load_dwordx4 v3, s[28:31], s41 offen offset:1024 nt lds
  buffer_load_dwordx4 v4, s[28:31], s41 offen offset:2048 nt lds
  buffer_load_dwordx4 v5, s[28:31], s41 offen offset:3072 nt lds
  v_mfma_f32_16x16x32_bf16 v[216:219], v[92:95], v[60:63], 0
  v_mfma_f32_16x16x32_bf16 v[216:219], v[96:99], v[64:67], v[216:219]
  v_mfma_f32_16x16x32_bf16 v[216:219], v[100:103], v[68:71], v[216:219]
  v_mfma_f32_16x16x32_bf16 v[216:219], v[104:107], v[72:75], v[216:219]
  v_mfma_f32_16x16x32_bf16 v[216:219], v[108:111], v[76:79], v[216:219]
  v_mfma_f32_16x16x32_bf16 v[216:219], v[112:115], v[80:83], v[216:219]
  v_mfma_f32_16x16x32_bf16 v[216:219], v[116:119], v[84:87], v[216:219]
  v_mfma_f32_16x16x32_bf16 v[216:219], v[120:123], v[88:91], v[216:219]
  s_nop 7
  v_cvt_pk_bf16_f32 v26, v216, v217
  v_lshlrev_b32 v216, 16, v26
  v_and_b32 v217, 0xffff0000, v26
  v_cvt_pk_bf16_f32 v27, v218, v219
  v_lshlrev_b32 v218, 16, v27
  v_and_b32 v219, 0xffff0000, v27
  v_max3_f32 v252, v252, v216, v217
  v_max3_f32 v252, v252, v218, v219
  v_mov_b32 v21, v252
  v_mov_b32 v22, v252
  s_nop 1
  v_permlane16_swap_b32 v21, v22
  s_nop 1
  v_max_f32 v252, v21, v22
  v_mov_b32 v21, v252
  v_mov_b32 v22, v252
  s_nop 1
  v_permlane32_swap_b32 v21, v22
  s_nop 1
  v_max_f32 v252, v21, v22
  v_mul_f32 v20, s96, v252
  v_max_f32 v20, v20, v18
  v_sub_f32 v21, v18, v20
  v_exp_f32 v21, v21
  v_mov_b32 v18, v20
  v_mul_f32 v19, v19, v21
  v_mul_f32 v36, v36, v21
  v_mul_f32 v37, v37, v21
  v_mul_f32 v38, v38, v21
  v_mul_f32 v39, v39, v21
  v_mul_f32 v40, v40, v21
  v_mul_f32 v41, v41, v21
  v_mul_f32 v42, v42, v21
  v_mul_f32 v43, v43, v21
  s_add_u32 s40, s64, 131072
  s_add_u32 s41, s40, 4096
  ds_read_b64_tr_b16 v[92:93], v10 offset:0
  ds_read_b64_tr_b16 v[94:95], v11 offset:0
  ds_read_b64_tr_b16 v[96:97], v12 offset:0
  ds_read_b64_tr_b16 v[98:99], v13 offset:0
  ds_read_b64_tr_b16 v[100:101], v14 offset:0
  ds_read_b64_tr_b16 v[102:103], v15 offset:0
  ds_read_b64_tr_b16 v[104:105], v16 offset:0
  ds_read_b64_tr_b16 v[106:107], v17 offset:0
  ds_read_b64_tr_b16 v[108:109], v10 offset:256
  ds_read_b64_tr_b16 v[110:111], v11 offset:256
  ds_read_b64_tr_b16 v[112:113], v12 offset:256
  ds_read_b64_tr_b16 v[114:115], v13 offset:256
  ds_read_b64_tr_b16 v[116:117], v14 offset:256
  ds_read_b64_tr_b16 v[118:119], v15 offset:256
  ds_read_b64_tr_b16 v[120:121], v16 offset:256
  ds_read_b64_tr_b16 v[122:123], v17 offset:256
  v_fma_f32 v124, v124, s96, -v18
  v_fma_f32 v125, v125, s96, -v18
  v_fma_f32 v126, v126, s96, -v18
  v_fma_f32 v127, v127, s96, -v18
  v_exp_f32 v124, v124
  v_exp_f32 v125, v125
  v_exp_f32 v126, v126
  v_exp_f32 v127, v127
  s_nop 0
  v_add_f32 v24, v124, v125
  v_add_f32 v25, v126, v127
  v_cvt_pk_bf16_f32 v124, v124, v125
  v_cvt_pk_bf16_f32 v125, v126, v127
  v_add_f32 v24, v24, v25
  v_add_f32 v19, v19, v24
  v_cndmask_b32 v44, 0, v124, s[48:49]
  v_cndmask_b32 v45, 0, v125, s[48:49]
  v_cndmask_b32 v46, 0, v124, s[50:51]
  v_cndmask_b32 v47, 0, v125, s[50:51]
  v_cndmask_b32 v48, 0, v124, s[52:53]
  v_cndmask_b32 v49, 0, v125, s[52:53]
  v_cndmask_b32 v50, 0, v124, s[54:55]
  v_cndmask_b32 v51, 0, v125, s[54:55]
  v_cndmask_b32 v52, 0, v124, s[56:57]
  v_cndmask_b32 v53, 0, v125, s[56:57]
  v_cndmask_b32 v54, 0, v124, s[58:59]
  v_cndmask_b32 v55, 0, v125, s[58:59]
  v_cndmask_b32 v56, 0, v124, s[60:61]
  v_cndmask_b32 v57, 0, v125, s[60:61]
  v_cndmask_b32 v58, 0, v124, s[62:63]
  v_cndmask_b32 v59, 0, v125, s[62:63]
  s_waitcnt lgkmcnt(0)
  s_waitcnt vmcnt(0)
  s_add_u32 m0, s42, 0
  s_nop 0
  buffer_load_dwordx4 v2, s[28:31], s40 offen offset:0 nt lds
  buffer_load_dwordx4 v3, s[28:31], s40 offen offset:1024 nt lds
  buffer_load_dwordx4 v4, s[28:31], s40 offen offset:2048 nt lds
  buffer_load_dwordx4 v5, s[28:31], s40 offen offset:3072 nt lds
  s_add_u32 m0, s42, 4096
  s_nop 0
  buffer_load_dwordx4 v2, s[28:31], s41 offen offset:0 nt lds
  buffer_load_dwordx4 v3, s[28:31], s41 offen offset:1024 nt lds
  buffer_load_dwordx4 v4, s[28:31], s41 offen offset:2048 nt lds
  buffer_load_dwordx4 v5, s[28:31], s41 offen offset:3072 nt lds
  v_mfma_f32_16x16x16_bf16 v[36:39], v[92:93], v[44:45], v[36:39]
  v_mfma_f32_16x16x16_bf16 v[40:43], v[108:109], v[44:45], v[40:43]
  v_mfma_f32_16x16x16_bf16 v[36:39], v[94:95], v[46:47], v[36:39]
  v_mfma_f32_16x16x16_bf16 v[40:43], v[110:111], v[46:47], v[40:43]
  v_mfma_f32_16x16x16_bf16 v[36:39], v[96:97], v[48:49], v[36:39]
  v_mfma_f32_16x16x16_bf16 v[40:43], v[112:113], v[48:49], v[40:43]
  v_mfma_f32_16x16x16_bf16 v[36:39], v[98:99], v[50:51], v[36:39]
  v_mfma_f32_16x16x16_bf16 v[40:43], v[114:115], v[50:51], v[40:43]
  v_mfma_f32_16x16x16_bf16 v[36:39], v[100:101], v[52:53], v[36:39]
  v_mfma_f32_16x16x16_bf16 v[40:43], v[116:117], v[52:53], v[40:43]
  v_mfma_f32_16x16x16_bf16 v[36:39], v[102:103], v[54:55], v[36:39]
  v_mfma_f32_16x16x16_bf16 v[40:43], v[118:119], v[54:55], v[40:43]
  v_mfma_f32_16x16x16_bf16 v[36:39], v[104:105], v[56:57], v[36:39]
  v_mfma_f32_16x16x16_bf16 v[40:43], v[120:121], v[56:57], v[40:43]
  v_mfma_f32_16x16x16_bf16 v[36:39], v[106:107], v[58:59], v[36:39]
  v_mfma_f32_16x16x16_bf16 v[40:43], v[122:123], v[58:59], v[40:43]
  s_add_u32 s40, s64, 163840
  s_add_u32 s41, s40, 4096
  ds_read_b64_tr_b16 v[92:93], v10 offset:8192
  ds_read_b64_tr_b16 v[94:95], v11 offset:8192
  ds_read_b64_tr_b16 v[96:97], v12 offset:8192
  ds_read_b64_tr_b16 v[98:99], v13 offset:8192
  ds_read_b64_tr_b16 v[100:101], v14 offset:8192
  ds_read_b64_tr_b16 v[102:103], v15 offset:8192
  ds_read_b64_tr_b16 v[104:105], v16 offset:8192
  ds_read_b64_tr_b16 v[106:107], v17 offset:8192
  ds_read_b64_tr_b16 v[108:109], v10 offset:8448
  ds_read_b64_tr_b16 v[110:111], v11 offset:8448
  ds_read_b64_tr_b16 v[112:113], v12 offset:8448
  ds_read_b64_tr_b16 v[114:115], v13 offset:8448
  ds_read_b64_tr_b16 v[116:117], v14 offset:8448
  ds_read_b64_tr_b16 v[118:119], v15 offset:8448
  ds_read_b64_tr_b16 v[120:121], v16 offset:8448
  ds_read_b64_tr_b16 v[122:123], v17 offset:8448
  v_fma_f32 v128, v128, s96, -v18
  v_fma_f32 v129, v129, s96, -v18
  v_fma_f32 v130, v130, s96, -v18
  v_fma_f32 v131, v131, s96, -v18
  v_exp_f32 v128, v128
  v_exp_f32 v129, v129
  v_exp_f32 v130, v130
  v_exp_f32 v131, v131
  s_nop 0
  v_add_f32 v24, v128, v129
  v_add_f32 v25, v130, v131
  v_cvt_pk_bf16_f32 v128, v128, v129
  v_cvt_pk_bf16_f32 v129, v130, v131
  v_add_f32 v24, v24, v25
  v_add_f32 v19, v19, v24
  v_cndmask_b32 v44, 0, v128, s[48:49]
  v_cndmask_b32 v45, 0, v129, s[48:49]
  v_cndmask_b32 v46, 0, v128, s[50:51]
  v_cndmask_b32 v47, 0, v129, s[50:51]
  v_cndmask_b32 v48, 0, v128, s[52:53]
  v_cndmask_b32 v49, 0, v129, s[52:53]
  v_cndmask_b32 v50, 0, v128, s[54:55]
  v_cndmask_b32 v51, 0, v129, s[54:55]
  v_cndmask_b32 v52, 0, v128, s[56:57]
  v_cndmask_b32 v53, 0, v129, s[56:57]
  v_cndmask_b32 v54, 0, v128, s[58:59]
  v_cndmask_b32 v55, 0, v129, s[58:59]
  v_cndmask_b32 v56, 0, v128, s[60:61]
  v_cndmask_b32 v57, 0, v129, s[60:61]
  v_cndmask_b32 v58, 0, v128, s[62:63]
  v_cndmask_b32 v59, 0, v129, s[62:63]
  s_waitcnt lgkmcnt(0)
  s_waitcnt vmcnt(0)
  s_add_u32 m0, s42, 8192
  s_nop 0
  buffer_load_dwordx4 v2, s[28:31], s40 offen offset:0 nt lds
  buffer_load_dwordx4 v3, s[28:31], s40 offen offset:1024 nt lds
  buffer_load_dwordx4 v4, s[28:31], s40 offen offset:2048 nt lds
  buffer_load_dwordx4 v5, s[28:31], s40 offen offset:3072 nt lds
  s_add_u32 m0, s42, 12288
  s_nop 0
  buffer_load_dwordx4 v2, s[28:31], s41 offen offset:0 nt lds
  buffer_load_dwordx4 v3, s[28:31], s41 offen offset:1024 nt lds
  buffer_load_dwordx4 v4, s[28:31], s41 offen offset:2048 nt lds
  buffer_load_dwordx4 v5, s[28:31], s41 offen offset:3072 nt lds
  v_mfma_f32_16x16x16_bf16 v[36:39], v[92:93], v[44:45], v[36:39]
  v_mfma_f32_16x16x16_bf16 v[40:43], v[108:109], v[44:45], v[40:43]
  v_mfma_f32_16x16x16_bf16 v[36:39], v[94:95], v[46:47], v[36:39]
  v_mfma_f32_16x16x16_bf16 v[40:43], v[110:111], v[46:47], v[40:43]
  v_mfma_f32_16x16x16_bf16 v[36:39], v[96:97], v[48:49], v[36:39]
  v_mfma_f32_16x16x16_bf16 v[40:43], v[112:113], v[48:49], v[40:43]
  v_mfma_f32_16x16x16_bf16 v[36:39], v[98:99], v[50:51], v[36:39]
  v_mfma_f32_16x16x16_bf16 v[40:43], v[114:115], v[50:51], v[40:43]
  v_mfma_f32_16x16x16_bf16 v[36:39], v[100:101], v[52:53], v[36:39]
  v_mfma_f32_16x16x16_bf16 v[40:43], v[116:117], v[52:53], v[40:43]
  v_mfma_f32_16x16x16_bf16 v[36:39], v[102:103], v[54:55], v[36:39]
  v_mfma_f32_16x16x16_bf16 v[40:43], v[118:119], v[54:55], v[40:43]
  v_mfma_f32_16x16x16_bf16 v[36:39], v[104:105], v[56:57], v[36:39]
  v_mfma_f32_16x16x16_bf16 v[40:43], v[120:121], v[56:57], v[40:43]
  v_mfma_f32_16x16x16_bf16 v[36:39], v[106:107], v[58:59], v[36:39]
  v_mfma_f32_16x16x16_bf16 v[40:43], v[122:123], v[58:59], v[40:43]
  s_add_u32 s40, s64, 196608
  s_add_u32 s41, s40, 4096
  ds_read_b64_tr_b16 v[92:93], v10 offset:16384
  ds_read_b64_tr_b16 v[94:95], v11 offset:16384
  ds_read_b64_tr_b16 v[96:97], v12 offset:16384
  ds_read_b64_tr_b16 v[98:99], v13 offset:16384
  ds_read_b64_tr_b16 v[100:101], v14 offset:16384
  ds_read_b64_tr_b16 v[102:103], v15 offset:16384
  ds_read_b64_tr_b16 v[104:105], v16 offset:16384
  ds_read_b64_tr_b16 v[106:107], v17 offset:16384
  ds_read_b64_tr_b16 v[108:109], v10 offset:16640
  ds_read_b64_tr_b16 v[110:111], v11 offset:16640
  ds_read_b64_tr_b16 v[112:113], v12 offset:16640
  ds_read_b64_tr_b16 v[114:115], v13 offset:16640
  ds_read_b64_tr_b16 v[116:117], v14 offset:16640
  ds_read_b64_tr_b16 v[118:119], v15 offset:16640
  ds_read_b64_tr_b16 v[120:121], v16 offset:16640
  ds_read_b64_tr_b16 v[122:123], v17 offset:16640
  v_fma_f32 v132, v132, s96, -v18
  v_fma_f32 v133, v133, s96, -v18
  v_fma_f32 v134, v134, s96, -v18
  v_fma_f32 v135, v135, s96, -v18
  v_exp_f32 v132, v132
  v_exp_f32 v133, v133
  v_exp_f32 v134, v134
  v_exp_f32 v135, v135
  s_nop 0
  v_add_f32 v24, v132, v133
  v_add_f32 v25, v134, v135
  v_cvt_pk_bf16_f32 v132, v132, v133
  v_cvt_pk_bf16_f32 v133, v134, v135
  v_add_f32 v24, v24, v25
  v_add_f32 v19, v19, v24
  v_cndmask_b32 v44, 0, v132, s[48:49]
  v_cndmask_b32 v45, 0, v133, s[48:49]
  v_cndmask_b32 v46, 0, v132, s[50:51]
  v_cndmask_b32 v47, 0, v133, s[50:51]
  v_cndmask_b32 v48, 0, v132, s[52:53]
  v_cndmask_b32 v49, 0, v133, s[52:53]
  v_cndmask_b32 v50, 0, v132, s[54:55]
  v_cndmask_b32 v51, 0, v133, s[54:55]
  v_cndmask_b32 v52, 0, v132, s[56:57]
  v_cndmask_b32 v53, 0, v133, s[56:57]
  v_cndmask_b32 v54, 0, v132, s[58:59]
  v_cndmask_b32 v55, 0, v133, s[58:59]
  v_cndmask_b32 v56, 0, v132, s[60:61]
  v_cndmask_b32 v57, 0, v133, s[60:61]
  v_cndmask_b32 v58, 0, v132, s[62:63]
  v_cndmask_b32 v59, 0, v133, s[62:63]
  s_waitcnt lgkmcnt(0)
  s_waitcnt vmcnt(0)
  s_add_u32 m0, s42, 16384
  s_nop 0
  buffer_load_dwordx4 v2, s[28:31], s40 offen offset:0 nt lds
  buffer_load_dwordx4 v3, s[28:31], s40 offen offset:1024 nt lds
  buffer_load_dwordx4 v4, s[28:31], s40 offen offset:2048 nt lds
  buffer_load_dwordx4 v5, s[28:31], s40 offen offset:3072 nt lds
  s_add_u32 m0, s42, 20480
  s_nop 0
  buffer_load_dwordx4 v2, s[28:31], s41 offen offset:0 nt lds
  buffer_load_dwordx4 v3, s[28:31], s41 offen offset:1024 nt lds
  buffer_load_dwordx4 v4, s[28:31], s41 offen offset:2048 nt lds
  buffer_load_dwordx4 v5, s[28:31], s41 offen offset:3072 nt lds
  v_mfma_f32_16x16x16_bf16 v[36:39], v[92:93], v[44:45], v[36:39]
  v_mfma_f32_16x16x16_bf16 v[40:43], v[108:109], v[44:45], v[40:43]
  v_mfma_f32_16x16x16_bf16 v[36:39], v[94:95], v[46:47], v[36:39]
  v_mfma_f32_16x16x16_bf16 v[40:43], v[110:111], v[46:47], v[40:43]
  v_mfma_f32_16x16x16_bf16 v[36:39], v[96:97], v[48:49], v[36:39]
  v_mfma_f32_16x16x16_bf16 v[40:43], v[112:113], v[48:49], v[40:43]
  v_mfma_f32_16x16x16_bf16 v[36:39], v[98:99], v[50:51], v[36:39]
  v_mfma_f32_16x16x16_bf16 v[40:43], v[114:115], v[50:51], v[40:43]
  v_mfma_f32_16x16x16_bf16 v[36:39], v[100:101], v[52:53], v[36:39]
  v_mfma_f32_16x16x16_bf16 v[40:43], v[116:117], v[52:53], v[40:43]
  v_mfma_f32_16x16x16_bf16 v[36:39], v[102:103], v[54:55], v[36:39]
  v_mfma_f32_16x16x16_bf16 v[40:43], v[118:119], v[54:55], v[40:43]
  v_mfma_f32_16x16x16_bf16 v[36:39], v[104:105], v[56:57], v[36:39]
  v_mfma_f32_16x16x16_bf16 v[40:43], v[120:121], v[56:57], v[40:43]
  v_mfma_f32_16x16x16_bf16 v[36:39], v[106:107], v[58:59], v[36:39]
  v_mfma_f32_16x16x16_bf16 v[40:43], v[122:123], v[58:59], v[40:43]
  s_add_u32 s40, s64, 229376
  s_add_u32 s41, s40, 4096
  ds_read_b64_tr_b16 v[92:93], v10 offset:24576
  ds_read_b64_tr_b16 v[94:95], v11 offset:24576
  ds_read_b64_tr_b16 v[96:97], v12 offset:24576
  ds_read_b64_tr_b16 v[98:99], v13 offset:24576
  ds_read_b64_tr_b16 v[100:101], v14 offset:24576
  ds_read_b64_tr_b16 v[102:103], v15 offset:24576
  ds_read_b64_tr_b16 v[104:105], v16 offset:24576
  ds_read_b64_tr_b16 v[106:107], v17 offset:24576
  ds_read_b64_tr_b16 v[108:109], v10 offset:24832
  ds_read_b64_tr_b16 v[110:111], v11 offset:24832
  ds_read_b64_tr_b16 v[112:113], v12 offset:24832
  ds_read_b64_tr_b16 v[114:115], v13 offset:24832
  ds_read_b64_tr_b16 v[116:117], v14 offset:24832
  ds_read_b64_tr_b16 v[118:119], v15 offset:24832
  ds_read_b64_tr_b16 v[120:121], v16 offset:24832
  ds_read_b64_tr_b16 v[122:123], v17 offset:24832
  v_fma_f32 v136, v136, s96, -v18
  v_fma_f32 v137, v137, s96, -v18
  v_fma_f32 v138, v138, s96, -v18
  v_fma_f32 v139, v139, s96, -v18
  v_exp_f32 v136, v136
  v_exp_f32 v137, v137
  v_exp_f32 v138, v138
  v_exp_f32 v139, v139
  s_nop 0
  v_add_f32 v24, v136, v137
  v_add_f32 v25, v138, v139
  v_cvt_pk_bf16_f32 v136, v136, v137
  v_cvt_pk_bf16_f32 v137, v138, v139
  v_add_f32 v24, v24, v25
  v_add_f32 v19, v19, v24
  v_cndmask_b32 v44, 0, v136, s[48:49]
  v_cndmask_b32 v45, 0, v137, s[48:49]
  v_cndmask_b32 v46, 0, v136, s[50:51]
  v_cndmask_b32 v47, 0, v137, s[50:51]
  v_cndmask_b32 v48, 0, v136, s[52:53]
  v_cndmask_b32 v49, 0, v137, s[52:53]
  v_cndmask_b32 v50, 0, v136, s[54:55]
  v_cndmask_b32 v51, 0, v137, s[54:55]
  v_cndmask_b32 v52, 0, v136, s[56:57]
  v_cndmask_b32 v53, 0, v137, s[56:57]
  v_cndmask_b32 v54, 0, v136, s[58:59]
  v_cndmask_b32 v55, 0, v137, s[58:59]
  v_cndmask_b32 v56, 0, v136, s[60:61]
  v_cndmask_b32 v57, 0, v137, s[60:61]
  v_cndmask_b32 v58, 0, v136, s[62:63]
  v_cndmask_b32 v59, 0, v137, s[62:63]
  s_waitcnt lgkmcnt(0)
  s_waitcnt vmcnt(0)
  s_add_u32 m0, s42, 24576
  s_nop 0
  buffer_load_dwordx4 v2, s[28:31], s40 offen offset:0 nt lds
  buffer_load_dwordx4 v3, s[28:31], s40 offen offset:1024 nt lds
  buffer_load_dwordx4 v4, s[28:31], s40 offen offset:2048 nt lds
  buffer_load_dwordx4 v5, s[28:31], s40 offen offset:3072 nt lds
  s_add_u32 m0, s42, 28672
  s_nop 0
  buffer_load_dwordx4 v2, s[28:31], s41 offen offset:0 nt lds
  buffer_load_dwordx4 v3, s[28:31], s41 offen offset:1024 nt lds
  buffer_load_dwordx4 v4, s[28:31], s41 offen offset:2048 nt lds
  buffer_load_dwordx4 v5, s[28:31], s41 offen offset:3072 nt lds
  v_mfma_f32_16x16x16_bf16 v[36:39], v[92:93], v[44:45], v[36:39]
  v_mfma_f32_16x16x16_bf16 v[40:43], v[108:109], v[44:45], v[40:43]
  v_mfma_f32_16x16x16_bf16 v[36:39], v[94:95], v[46:47], v[36:39]
  v_mfma_f32_16x16x16_bf16 v[40:43], v[110:111], v[46:47], v[40:43]
  v_mfma_f32_16x16x16_bf16 v[36:39], v[96:97], v[48:49], v[36:39]
  v_mfma_f32_16x16x16_bf16 v[40:43], v[112:113], v[48:49], v[40:43]
  v_mfma_f32_16x16x16_bf16 v[36:39], v[98:99], v[50:51], v[36:39]
  v_mfma_f32_16x16x16_bf16 v[40:43], v[114:115], v[50:51], v[40:43]
  v_mfma_f32_16x16x16_bf16 v[36:39], v[100:101], v[52:53], v[36:39]
  v_mfma_f32_16x16x16_bf16 v[40:43], v[116:117], v[52:53], v[40:43]
  v_mfma_f32_16x16x16_bf16 v[36:39], v[102:103], v[54:55], v[36:39]
  v_mfma_f32_16x16x16_bf16 v[40:43], v[118:119], v[54:55], v[40:43]
  v_mfma_f32_16x16x16_bf16 v[36:39], v[104:105], v[56:57], v[36:39]
  v_mfma_f32_16x16x16_bf16 v[40:43], v[120:121], v[56:57], v[40:43]
  v_mfma_f32_16x16x16_bf16 v[36:39], v[106:107], v[58:59], v[36:39]
  v_mfma_f32_16x16x16_bf16 v[40:43], v[122:123], v[58:59], v[40:43]
  s_add_u32 s40, s64, 262144
  s_add_u32 s41, s40, 4096
  ds_read_b64_tr_b16 v[92:93], v10 offset:0
  ds_read_b64_tr_b16 v[94:95], v11 offset:0
  ds_read_b64_tr_b16 v[96:97], v12 offset:0
  ds_read_b64_tr_b16 v[98:99], v13 offset:0
  ds_read_b64_tr_b16 v[100:101], v14 offset:0
  ds_read_b64_tr_b16 v[102:103], v15 offset:0
  ds_read_b64_tr_b16 v[104:105], v16 offset:0
  ds_read_b64_tr_b16 v[106:107], v17 offset:0
  ds_read_b64_tr_b16 v[108:109], v10 offset:256
  ds_read_b64_tr_b16 v[110:111], v11 offset:256
  ds_read_b64_tr_b16 v[112:113], v12 offset:256
  ds_read_b64_tr_b16 v[114:115], v13 offset:256
  ds_read_b64_tr_b16 v[116:117], v14 offset:256
  ds_read_b64_tr_b16 v[118:119], v15 offset:256
  ds_read_b64_tr_b16 v[120:121], v16 offset:256
  ds_read_b64_tr_b16 v[122:123], v17 offset:256
  v_fma_f32 v140, v140, s96, -v18
  v_fma_f32 v141, v141, s96, -v18
  v_fma_f32 v142, v142, s96, -v18
  v_fma_f32 v143, v143, s96, -v18
  v_exp_f32 v140, v140
  v_exp_f32 v141, v141
  v_exp_f32 v142, v142
  v_exp_f32 v143, v143
  s_nop 0
  v_add_f32 v24, v140, v141
  v_add_f32 v25, v142, v143
  v_cvt_pk_bf16_f32 v140, v140, v141
  v_cvt_pk_bf16_f32 v141, v142, v143
  v_add_f32 v24, v24, v25
  v_add_f32 v19, v19, v24
  v_cndmask_b32 v44, 0, v140, s[48:49]
  v_cndmask_b32 v45, 0, v141, s[48:49]
  v_cndmask_b32 v46, 0, v140, s[50:51]
  v_cndmask_b32 v47, 0, v141, s[50:51]
  v_cndmask_b32 v48, 0, v140, s[52:53]
  v_cndmask_b32 v49, 0, v141, s[52:53]
  v_cndmask_b32 v50, 0, v140, s[54:55]
  v_cndmask_b32 v51, 0, v141, s[54:55]
  v_cndmask_b32 v52, 0, v140, s[56:57]
  v_cndmask_b32 v53, 0, v141, s[56:57]
  v_cndmask_b32 v54, 0, v140, s[58:59]
  v_cndmask_b32 v55, 0, v141, s[58:59]
  v_cndmask_b32 v56, 0, v140, s[60:61]
  v_cndmask_b32 v57, 0, v141, s[60:61]
  v_cndmask_b32 v58, 0, v140, s[62:63]
  v_cndmask_b32 v59, 0, v141, s[62:63]
  s_waitcnt lgkmcnt(0)
  s_waitcnt vmcnt(0)
  s_add_u32 m0, s42, 0
  s_nop 0
  buffer_load_dwordx4 v2, s[28:31], s40 offen offset:0 nt lds
  buffer_load_dwordx4 v3, s[28:31], s40 offen offset:1024 nt lds
  buffer_load_dwordx4 v4, s[28:31], s40 offen offset:2048 nt lds
  buffer_load_dwordx4 v5, s[28:31], s40 offen offset:3072 nt lds
  s_add_u32 m0, s42, 4096
  s_nop 0
  buffer_load_dwordx4 v2, s[28:31], s41 offen offset:0 nt lds
  buffer_load_dwordx4 v3, s[28:31], s41 offen offset:1024 nt lds
  buffer_load_dwordx4 v4, s[28:31], s41 offen offset:2048 nt lds
  buffer_load_dwordx4 v5, s[28:31], s41 offen offset:3072 nt lds
  v_mfma_f32_16x16x16_bf16 v[36:39], v[92:93], v[44:45], v[36:39]
  v_mfma_f32_16x16x16_bf16 v[40:43], v[108:109], v[44:45], v[40:43]
  v_mfma_f32_16x16x16_bf16 v[36:39], v[94:95], v[46:47], v[36:39]
  v_mfma_f32_16x16x16_bf16 v[40:43], v[110:111], v[46:47], v[40:43]
  v_mfma_f32_16x16x16_bf16 v[36:39], v[96:97], v[48:49], v[36:39]
  v_mfma_f32_16x16x16_bf16 v[40:43], v[112:113], v[48:49], v[40:43]
  v_mfma_f32_16x16x16_bf16 v[36:39], v[98:99], v[50:51], v[36:39]
  v_mfma_f32_16x16x16_bf16 v[40:43], v[114:115], v[50:51], v[40:43]
  v_mfma_f32_16x16x16_bf16 v[36:39], v[100:101], v[52:53], v[36:39]
  v_mfma_f32_16x16x16_bf16 v[40:43], v[116:117], v[52:53], v[40:43]
  v_mfma_f32_16x16x16_bf16 v[36:39], v[102:103], v[54:55], v[36:39]
  v_mfma_f32_16x16x16_bf16 v[40:43], v[118:119], v[54:55], v[40:43]
  v_mfma_f32_16x16x16_bf16 v[36:39], v[104:105], v[56:57], v[36:39]
  v_mfma_f32_16x16x16_bf16 v[40:43], v[120:121], v[56:57], v[40:43]
  v_mfma_f32_16x16x16_bf16 v[36:39], v[106:107], v[58:59], v[36:39]
  v_mfma_f32_16x16x16_bf16 v[40:43], v[122:123], v[58:59], v[40:43]
  s_add_u32 s40, s64, 294912
  s_add_u32 s41, s40, 4096
  ds_read_b64_tr_b16 v[92:93], v10 offset:8192
  ds_read_b64_tr_b16 v[94:95], v11 offset:8192
  ds_read_b64_tr_b16 v[96:97], v12 offset:8192
  ds_read_b64_tr_b16 v[98:99], v13 offset:8192
  ds_read_b64_tr_b16 v[100:101], v14 offset:8192
  ds_read_b64_tr_b16 v[102:103], v15 offset:8192
  ds_read_b64_tr_b16 v[104:105], v16 offset:8192
  ds_read_b64_tr_b16 v[106:107], v17 offset:8192
  ds_read_b64_tr_b16 v[108:109], v10 offset:8448
  ds_read_b64_tr_b16 v[110:111], v11 offset:8448
  ds_read_b64_tr_b16 v[112:113], v12 offset:8448
  ds_read_b64_tr_b16 v[114:115], v13 offset:8448
  ds_read_b64_tr_b16 v[116:117], v14 offset:8448
  ds_read_b64_tr_b16 v[118:119], v15 offset:8448
  ds_read_b64_tr_b16 v[120:121], v16 offset:8448
  ds_read_b64_tr_b16 v[122:123], v17 offset:8448
  v_fma_f32 v144, v144, s96, -v18
  v_fma_f32 v145, v145, s96, -v18
  v_fma_f32 v146, v146, s96, -v18
  v_fma_f32 v147, v147, s96, -v18
  v_exp_f32 v144, v144
  v_exp_f32 v145, v145
  v_exp_f32 v146, v146
  v_exp_f32 v147, v147
  s_nop 0
  v_add_f32 v24, v144, v145
  v_add_f32 v25, v146, v147
  v_cvt_pk_bf16_f32 v144, v144, v145
  v_cvt_pk_bf16_f32 v145, v146, v147
  v_add_f32 v24, v24, v25
  v_add_f32 v19, v19, v24
  v_cndmask_b32 v44, 0, v144, s[48:49]
  v_cndmask_b32 v45, 0, v145, s[48:49]
  v_cndmask_b32 v46, 0, v144, s[50:51]
  v_cndmask_b32 v47, 0, v145, s[50:51]
  v_cndmask_b32 v48, 0, v144, s[52:53]
  v_cndmask_b32 v49, 0, v145, s[52:53]
  v_cndmask_b32 v50, 0, v144, s[54:55]
  v_cndmask_b32 v51, 0, v145, s[54:55]
  v_cndmask_b32 v52, 0, v144, s[56:57]
  v_cndmask_b32 v53, 0, v145, s[56:57]
  v_cndmask_b32 v54, 0, v144, s[58:59]
  v_cndmask_b32 v55, 0, v145, s[58:59]
  v_cndmask_b32 v56, 0, v144, s[60:61]
  v_cndmask_b32 v57, 0, v145, s[60:61]
  v_cndmask_b32 v58, 0, v144, s[62:63]
  v_cndmask_b32 v59, 0, v145, s[62:63]
  s_waitcnt lgkmcnt(0)
  s_waitcnt vmcnt(0)
  s_add_u32 m0, s42, 8192
  s_nop 0
  buffer_load_dwordx4 v2, s[28:31], s40 offen offset:0 nt lds
  buffer_load_dwordx4 v3, s[28:31], s40 offen offset:1024 nt lds
  buffer_load_dwordx4 v4, s[28:31], s40 offen offset:2048 nt lds
  buffer_load_dwordx4 v5, s[28:31], s40 offen offset:3072 nt lds
  s_add_u32 m0, s42, 12288
  s_nop 0
  buffer_load_dwordx4 v2, s[28:31], s41 offen offset:0 nt lds
  buffer_load_dwordx4 v3, s[28:31], s41 offen offset:1024 nt lds
  buffer_load_dwordx4 v4, s[28:31], s41 offen offset:2048 nt lds
  buffer_load_dwordx4 v5, s[28:31], s41 offen offset:3072 nt lds
  v_mfma_f32_16x16x16_bf16 v[36:39], v[92:93], v[44:45], v[36:39]
  v_mfma_f32_16x16x16_bf16 v[40:43], v[108:109], v[44:45], v[40:43]
  v_mfma_f32_16x16x16_bf16 v[36:39], v[94:95], v[46:47], v[36:39]
  v_mfma_f32_16x16x16_bf16 v[40:43], v[110:111], v[46:47], v[40:43]
  v_mfma_f32_16x16x16_bf16 v[36:39], v[96:97], v[48:49], v[36:39]
  v_mfma_f32_16x16x16_bf16 v[40:43], v[112:113], v[48:49], v[40:43]
  v_mfma_f32_16x16x16_bf16 v[36:39], v[98:99], v[50:51], v[36:39]
  v_mfma_f32_16x16x16_bf16 v[40:43], v[114:115], v[50:51], v[40:43]
  v_mfma_f32_16x16x16_bf16 v[36:39], v[100:101], v[52:53], v[36:39]
  v_mfma_f32_16x16x16_bf16 v[40:43], v[116:117], v[52:53], v[40:43]
  v_mfma_f32_16x16x16_bf16 v[36:39], v[102:103], v[54:55], v[36:39]
  v_mfma_f32_16x16x16_bf16 v[40:43], v[118:119], v[54:55], v[40:43]
  v_mfma_f32_16x16x16_bf16 v[36:39], v[104:105], v[56:57], v[36:39]
  v_mfma_f32_16x16x16_bf16 v[40:43], v[120:121], v[56:57], v[40:43]
  v_mfma_f32_16x16x16_bf16 v[36:39], v[106:107], v[58:59], v[36:39]
  v_mfma_f32_16x16x16_bf16 v[40:43], v[122:123], v[58:59], v[40:43]
  s_add_u32 s40, s64, 327680
  s_add_u32 s41, s40, 4096
  ds_read_b64_tr_b16 v[92:93], v10 offset:16384
  ds_read_b64_tr_b16 v[94:95], v11 offset:16384
  ds_read_b64_tr_b16 v[96:97], v12 offset:16384
  ds_read_b64_tr_b16 v[98:99], v13 offset:16384
  ds_read_b64_tr_b16 v[100:101], v14 offset:16384
  ds_read_b64_tr_b16 v[102:103], v15 offset:16384
  ds_read_b64_tr_b16 v[104:105], v16 offset:16384
  ds_read_b64_tr_b16 v[106:107], v17 offset:16384
  ds_read_b64_tr_b16 v[108:109], v10 offset:16640
  ds_read_b64_tr_b16 v[110:111], v11 offset:16640
  ds_read_b64_tr_b16 v[112:113], v12 offset:16640
  ds_read_b64_tr_b16 v[114:115], v13 offset:16640
  ds_read_b64_tr_b16 v[116:117], v14 offset:16640
  ds_read_b64_tr_b16 v[118:119], v15 offset:16640
  ds_read_b64_tr_b16 v[120:121], v16 offset:16640
  ds_read_b64_tr_b16 v[122:123], v17 offset:16640
  v_fma_f32 v148, v148, s96, -v18
  v_fma_f32 v149, v149, s96, -v18
  v_fma_f32 v150, v150, s96, -v18
  v_fma_f32 v151, v151, s96, -v18
  v_exp_f32 v148, v148
  v_exp_f32 v149, v149
  v_exp_f32 v150, v150
  v_exp_f32 v151, v151
  s_nop 0
  v_add_f32 v24, v148, v149
  v_add_f32 v25, v150, v151
  v_cvt_pk_bf16_f32 v148, v148, v149
  v_cvt_pk_bf16_f32 v149, v150, v151
  v_add_f32 v24, v24, v25
  v_add_f32 v19, v19, v24
  v_cndmask_b32 v44, 0, v148, s[48:49]
  v_cndmask_b32 v45, 0, v149, s[48:49]
  v_cndmask_b32 v46, 0, v148, s[50:51]
  v_cndmask_b32 v47, 0, v149, s[50:51]
  v_cndmask_b32 v48, 0, v148, s[52:53]
  v_cndmask_b32 v49, 0, v149, s[52:53]
  v_cndmask_b32 v50, 0, v148, s[54:55]
  v_cndmask_b32 v51, 0, v149, s[54:55]
  v_cndmask_b32 v52, 0, v148, s[56:57]
  v_cndmask_b32 v53, 0, v149, s[56:57]
  v_cndmask_b32 v54, 0, v148, s[58:59]
  v_cndmask_b32 v55, 0, v149, s[58:59]
  v_cndmask_b32 v56, 0, v148, s[60:61]
  v_cndmask_b32 v57, 0, v149, s[60:61]
  v_cndmask_b32 v58, 0, v148, s[62:63]
  v_cndmask_b32 v59, 0, v149, s[62:63]
  s_waitcnt lgkmcnt(0)
  s_waitcnt vmcnt(0)
  s_add_u32 m0, s42, 16384
  s_nop 0
  buffer_load_dwordx4 v2, s[28:31], s40 offen offset:0 nt lds
  buffer_load_dwordx4 v3, s[28:31], s40 offen offset:1024 nt lds
  buffer_load_dwordx4 v4, s[28:31], s40 offen offset:2048 nt lds
  buffer_load_dwordx4 v5, s[28:31], s40 offen offset:3072 nt lds
  s_add_u32 m0, s42, 20480
  s_nop 0
  buffer_load_dwordx4 v2, s[28:31], s41 offen offset:0 nt lds
  buffer_load_dwordx4 v3, s[28:31], s41 offen offset:1024 nt lds
  buffer_load_dwordx4 v4, s[28:31], s41 offen offset:2048 nt lds
  buffer_load_dwordx4 v5, s[28:31], s41 offen offset:3072 nt lds
  v_mfma_f32_16x16x16_bf16 v[36:39], v[92:93], v[44:45], v[36:39]
  v_mfma_f32_16x16x16_bf16 v[40:43], v[108:109], v[44:45], v[40:43]
  v_mfma_f32_16x16x16_bf16 v[36:39], v[94:95], v[46:47], v[36:39]
  v_mfma_f32_16x16x16_bf16 v[40:43], v[110:111], v[46:47], v[40:43]
  v_mfma_f32_16x16x16_bf16 v[36:39], v[96:97], v[48:49], v[36:39]
  v_mfma_f32_16x16x16_bf16 v[40:43], v[112:113], v[48:49], v[40:43]
  v_mfma_f32_16x16x16_bf16 v[36:39], v[98:99], v[50:51], v[36:39]
  v_mfma_f32_16x16x16_bf16 v[40:43], v[114:115], v[50:51], v[40:43]
  v_mfma_f32_16x16x16_bf16 v[36:39], v[100:101], v[52:53], v[36:39]
  v_mfma_f32_16x16x16_bf16 v[40:43], v[116:117], v[52:53], v[40:43]
  v_mfma_f32_16x16x16_bf16 v[36:39], v[102:103], v[54:55], v[36:39]
  v_mfma_f32_16x16x16_bf16 v[40:43], v[118:119], v[54:55], v[40:43]
  v_mfma_f32_16x16x16_bf16 v[36:39], v[104:105], v[56:57], v[36:39]
  v_mfma_f32_16x16x16_bf16 v[40:43], v[120:121], v[56:57], v[40:43]
  v_mfma_f32_16x16x16_bf16 v[36:39], v[106:107], v[58:59], v[36:39]
  v_mfma_f32_16x16x16_bf16 v[40:43], v[122:123], v[58:59], v[40:43]
  s_add_u32 s40, s64, 360448
  s_add_u32 s41, s40, 4096
  ds_read_b64_tr_b16 v[92:93], v10 offset:24576
  ds_read_b64_tr_b16 v[94:95], v11 offset:24576
  ds_read_b64_tr_b16 v[96:97], v12 offset:24576
  ds_read_b64_tr_b16 v[98:99], v13 offset:24576
  ds_read_b64_tr_b16 v[100:101], v14 offset:24576
  ds_read_b64_tr_b16 v[102:103], v15 offset:24576
  ds_read_b64_tr_b16 v[104:105], v16 offset:24576
  ds_read_b64_tr_b16 v[106:107], v17 offset:24576
  ds_read_b64_tr_b16 v[108:109], v10 offset:24832
  ds_read_b64_tr_b16 v[110:111], v11 offset:24832
  ds_read_b64_tr_b16 v[112:113], v12 offset:24832
  ds_read_b64_tr_b16 v[114:115], v13 offset:24832
  ds_read_b64_tr_b16 v[116:117], v14 offset:24832
  ds_read_b64_tr_b16 v[118:119], v15 offset:24832
  ds_read_b64_tr_b16 v[120:121], v16 offset:24832
  ds_read_b64_tr_b16 v[122:123], v17 offset:24832
  v_fma_f32 v152, v152, s96, -v18
  v_fma_f32 v153, v153, s96, -v18
  v_fma_f32 v154, v154, s96, -v18
  v_fma_f32 v155, v155, s96, -v18
  v_exp_f32 v152, v152
  v_exp_f32 v153, v153
  v_exp_f32 v154, v154
  v_exp_f32 v155, v155
  s_nop 0
  v_add_f32 v24, v152, v153
  v_add_f32 v25, v154, v155
  v_cvt_pk_bf16_f32 v152, v152, v153
  v_cvt_pk_bf16_f32 v153, v154, v155
  v_add_f32 v24, v24, v25
  v_add_f32 v19, v19, v24
  v_cndmask_b32 v44, 0, v152, s[48:49]
  v_cndmask_b32 v45, 0, v153, s[48:49]
  v_cndmask_b32 v46, 0, v152, s[50:51]
  v_cndmask_b32 v47, 0, v153, s[50:51]
  v_cndmask_b32 v48, 0, v152, s[52:53]
  v_cndmask_b32 v49, 0, v153, s[52:53]
  v_cndmask_b32 v50, 0, v152, s[54:55]
  v_cndmask_b32 v51, 0, v153, s[54:55]
  v_cndmask_b32 v52, 0, v152, s[56:57]
  v_cndmask_b32 v53, 0, v153, s[56:57]
  v_cndmask_b32 v54, 0, v152, s[58:59]
  v_cndmask_b32 v55, 0, v153, s[58:59]
  v_cndmask_b32 v56, 0, v152, s[60:61]
  v_cndmask_b32 v57, 0, v153, s[60:61]
  v_cndmask_b32 v58, 0, v152, s[62:63]
  v_cndmask_b32 v59, 0, v153, s[62:63]
  s_waitcnt lgkmcnt(0)
  s_waitcnt vmcnt(0)
  s_add_u32 m0, s42, 24576
  s_nop 0
  buffer_load_dwordx4 v2, s[28:31], s40 offen offset:0 nt lds
  buffer_load_dwordx4 v3, s[28:31], s40 offen offset:1024 nt lds
  buffer_load_dwordx4 v4, s[28:31], s40 offen offset:2048 nt lds
  buffer_load_dwordx4 v5, s[28:31], s40 offen offset:3072 nt lds
  s_add_u32 m0, s42, 28672
  s_nop 0
  buffer_load_dwordx4 v2, s[28:31], s41 offen offset:0 nt lds
  buffer_load_dwordx4 v3, s[28:31], s41 offen offset:1024 nt lds
  buffer_load_dwordx4 v4, s[28:31], s41 offen offset:2048 nt lds
  buffer_load_dwordx4 v5, s[28:31], s41 offen offset:3072 nt lds
  v_mfma_f32_16x16x16_bf16 v[36:39], v[92:93], v[44:45], v[36:39]
  v_mfma_f32_16x16x16_bf16 v[40:43], v[108:109], v[44:45], v[40:43]
  v_mfma_f32_16x16x16_bf16 v[36:39], v[94:95], v[46:47], v[36:39]
  v_mfma_f32_16x16x16_bf16 v[40:43], v[110:111], v[46:47], v[40:43]
  v_mfma_f32_16x16x16_bf16 v[36:39], v[96:97], v[48:49], v[36:39]
  v_mfma_f32_16x16x16_bf16 v[40:43], v[112:113], v[48:49], v[40:43]
  v_mfma_f32_16x16x16_bf16 v[36:39], v[98:99], v[50:51], v[36:39]
  v_mfma_f32_16x16x16_bf16 v[40:43], v[114:115], v[50:51], v[40:43]
  v_mfma_f32_16x16x16_bf16 v[36:39], v[100:101], v[52:53], v[36:39]
  v_mfma_f32_16x16x16_bf16 v[40:43], v[116:117], v[52:53], v[40:43]
  v_mfma_f32_16x16x16_bf16 v[36:39], v[102:103], v[54:55], v[36:39]
  v_mfma_f32_16x16x16_bf16 v[40:43], v[118:119], v[54:55], v[40:43]
  v_mfma_f32_16x16x16_bf16 v[36:39], v[104:105], v[56:57], v[36:39]
  v_mfma_f32_16x16x16_bf16 v[40:43], v[120:121], v[56:57], v[40:43]
  v_mfma_f32_16x16x16_bf16 v[36:39], v[106:107], v[58:59], v[36:39]
  v_mfma_f32_16x16x16_bf16 v[40:43], v[122:123], v[58:59], v[40:43]
  s_add_u32 s40, s64, 393216
  s_add_u32 s41, s40, 4096
  ds_read_b64_tr_b16 v[92:93], v10 offset:0
  ds_read_b64_tr_b16 v[94:95], v11 offset:0
  ds_read_b64_tr_b16 v[96:97], v12 offset:0
  ds_read_b64_tr_b16 v[98:99], v13 offset:0
  ds_read_b64_tr_b16 v[100:101], v14 offset:0
  ds_read_b64_tr_b16 v[102:103], v15 offset:0
  ds_read_b64_tr_b16 v[104:105], v16 offset:0
  ds_read_b64_tr_b16 v[106:107], v17 offset:0
  ds_read_b64_tr_b16 v[108:109], v10 offset:256
  ds_read_b64_tr_b16 v[110:111], v11 offset:256
  ds_read_b64_tr_b16 v[112:113], v12 offset:256
  ds_read_b64_tr_b16 v[114:115], v13 offset:256
  ds_read_b64_tr_b16 v[116:117], v14 offset:256
  ds_read_b64_tr_b16 v[118:119], v15 offset:256
  ds_read_b64_tr_b16 v[120:121], v16 offset:256
  ds_read_b64_tr_b16 v[122:123], v17 offset:256
  v_fma_f32 v156, v156, s96, -v18
  v_fma_f32 v157, v157, s96, -v18
  v_fma_f32 v158, v158, s96, -v18
  v_fma_f32 v159, v159, s96, -v18
  v_exp_f32 v156, v156
  v_exp_f32 v157, v157
  v_exp_f32 v158, v158
  v_exp_f32 v159, v159
  s_nop 0
  v_add_f32 v24, v156, v157
  v_add_f32 v25, v158, v159
  v_cvt_pk_bf16_f32 v156, v156, v157
  v_cvt_pk_bf16_f32 v157, v158, v159
  v_add_f32 v24, v24, v25
  v_add_f32 v19, v19, v24
  v_cndmask_b32 v44, 0, v156, s[48:49]
  v_cndmask_b32 v45, 0, v157, s[48:49]
  v_cndmask_b32 v46, 0, v156, s[50:51]
  v_cndmask_b32 v47, 0, v157, s[50:51]
  v_cndmask_b32 v48, 0, v156, s[52:53]
  v_cndmask_b32 v49, 0, v157, s[52:53]
  v_cndmask_b32 v50, 0, v156, s[54:55]
  v_cndmask_b32 v51, 0, v157, s[54:55]
  v_cndmask_b32 v52, 0, v156, s[56:57]
  v_cndmask_b32 v53, 0, v157, s[56:57]
  v_cndmask_b32 v54, 0, v156, s[58:59]
  v_cndmask_b32 v55, 0, v157, s[58:59]
  v_cndmask_b32 v56, 0, v156, s[60:61]
  v_cndmask_b32 v57, 0, v157, s[60:61]
  v_cndmask_b32 v58, 0, v156, s[62:63]
  v_cndmask_b32 v59, 0, v157, s[62:63]
  s_waitcnt lgkmcnt(0)
  s_waitcnt vmcnt(0)
  s_add_u32 m0, s42, 0
  s_nop 0
  buffer_load_dwordx4 v2, s[28:31], s40 offen offset:0 nt lds
  buffer_load_dwordx4 v3, s[28:31], s40 offen offset:1024 nt lds
  buffer_load_dwordx4 v4, s[28:31], s40 offen offset:2048 nt lds
  buffer_load_dwordx4 v5, s[28:31], s40 offen offset:3072 nt lds
  s_add_u32 m0, s42, 4096
  s_nop 0
  buffer_load_dwordx4 v2, s[28:31], s41 offen offset:0 nt lds
  buffer_load_dwordx4 v3, s[28:31], s41 offen offset:1024 nt lds
  buffer_load_dwordx4 v4, s[28:31], s41 offen offset:2048 nt lds
  buffer_load_dwordx4 v5, s[28:31], s41 offen offset:3072 nt lds
  v_mfma_f32_16x16x16_bf16 v[36:39], v[92:93], v[44:45], v[36:39]
  v_mfma_f32_16x16x16_bf16 v[40:43], v[108:109], v[44:45], v[40:43]
  v_mfma_f32_16x16x16_bf16 v[36:39], v[94:95], v[46:47], v[36:39]
  v_mfma_f32_16x16x16_bf16 v[40:43], v[110:111], v[46:47], v[40:43]
  v_mfma_f32_16x16x16_bf16 v[36:39], v[96:97], v[48:49], v[36:39]
  v_mfma_f32_16x16x16_bf16 v[40:43], v[112:113], v[48:49], v[40:43]
  v_mfma_f32_16x16x16_bf16 v[36:39], v[98:99], v[50:51], v[36:39]
  v_mfma_f32_16x16x16_bf16 v[40:43], v[114:115], v[50:51], v[40:43]
  v_mfma_f32_16x16x16_bf16 v[36:39], v[100:101], v[52:53], v[36:39]
  v_mfma_f32_16x16x16_bf16 v[40:43], v[116:117], v[52:53], v[40:43]
  v_mfma_f32_16x16x16_bf16 v[36:39], v[102:103], v[54:55], v[36:39]
  v_mfma_f32_16x16x16_bf16 v[40:43], v[118:119], v[54:55], v[40:43]
  v_mfma_f32_16x16x16_bf16 v[36:39], v[104:105], v[56:57], v[36:39]
  v_mfma_f32_16x16x16_bf16 v[40:43], v[120:121], v[56:57], v[40:43]
  v_mfma_f32_16x16x16_bf16 v[36:39], v[106:107], v[58:59], v[36:39]
  v_mfma_f32_16x16x16_bf16 v[40:43], v[122:123], v[58:59], v[40:43]
  s_add_u32 s40, s64, 425984
  s_add_u32 s41, s40, 4096
  ds_read_b64_tr_b16 v[92:93], v10 offset:8192
  ds_read_b64_tr_b16 v[94:95], v11 offset:8192
  ds_read_b64_tr_b16 v[96:97], v12 offset:8192
  ds_read_b64_tr_b16 v[98:99], v13 offset:8192
  ds_read_b64_tr_b16 v[100:101], v14 offset:8192
  ds_read_b64_tr_b16 v[102:103], v15 offset:8192
  ds_read_b64_tr_b16 v[104:105], v16 offset:8192
  ds_read_b64_tr_b16 v[106:107], v17 offset:8192
  ds_read_b64_tr_b16 v[108:109], v10 offset:8448
  ds_read_b64_tr_b16 v[110:111], v11 offset:8448
  ds_read_b64_tr_b16 v[112:113], v12 offset:8448
  ds_read_b64_tr_b16 v[114:115], v13 offset:8448
  ds_read_b64_tr_b16 v[116:117], v14 offset:8448
  ds_read_b64_tr_b16 v[118:119], v15 offset:8448
  ds_read_b64_tr_b16 v[120:121], v16 offset:8448
  ds_read_b64_tr_b16 v[122:123], v17 offset:8448
  v_fma_f32 v160, v160, s96, -v18
  v_fma_f32 v161, v161, s96, -v18
  v_fma_f32 v162, v162, s96, -v18
  v_fma_f32 v163, v163, s96, -v18
  v_exp_f32 v160, v160
  v_exp_f32 v161, v161
  v_exp_f32 v162, v162
  v_exp_f32 v163, v163
  s_nop 0
  v_add_f32 v24, v160, v161
  v_add_f32 v25, v162, v163
  v_cvt_pk_bf16_f32 v160, v160, v161
  v_cvt_pk_bf16_f32 v161, v162, v163
  v_add_f32 v24, v24, v25
  v_add_f32 v19, v19, v24
  v_cndmask_b32 v44, 0, v160, s[48:49]
  v_cndmask_b32 v45, 0, v161, s[48:49]
  v_cndmask_b32 v46, 0, v160, s[50:51]
  v_cndmask_b32 v47, 0, v161, s[50:51]
  v_cndmask_b32 v48, 0, v160, s[52:53]
  v_cndmask_b32 v49, 0, v161, s[52:53]
  v_cndmask_b32 v50, 0, v160, s[54:55]
  v_cndmask_b32 v51, 0, v161, s[54:55]
  v_cndmask_b32 v52, 0, v160, s[56:57]
  v_cndmask_b32 v53, 0, v161, s[56:57]
  v_cndmask_b32 v54, 0, v160, s[58:59]
  v_cndmask_b32 v55, 0, v161, s[58:59]
  v_cndmask_b32 v56, 0, v160, s[60:61]
  v_cndmask_b32 v57, 0, v161, s[60:61]
  v_cndmask_b32 v58, 0, v160, s[62:63]
  v_cndmask_b32 v59, 0, v161, s[62:63]
  s_waitcnt lgkmcnt(0)
  s_waitcnt vmcnt(0)
  s_add_u32 m0, s42, 8192
  s_nop 0
  buffer_load_dwordx4 v2, s[28:31], s40 offen offset:0 nt lds
  buffer_load_dwordx4 v3, s[28:31], s40 offen offset:1024 nt lds
  buffer_load_dwordx4 v4, s[28:31], s40 offen offset:2048 nt lds
  buffer_load_dwordx4 v5, s[28:31], s40 offen offset:3072 nt lds
  s_add_u32 m0, s42, 12288
  s_nop 0
  buffer_load_dwordx4 v2, s[28:31], s41 offen offset:0 nt lds
  buffer_load_dwordx4 v3, s[28:31], s41 offen offset:1024 nt lds
  buffer_load_dwordx4 v4, s[28:31], s41 offen offset:2048 nt lds
  buffer_load_dwordx4 v5, s[28:31], s41 offen offset:3072 nt lds
  v_mfma_f32_16x16x16_bf16 v[36:39], v[92:93], v[44:45], v[36:39]
  v_mfma_f32_16x16x16_bf16 v[40:43], v[108:109], v[44:45], v[40:43]
  v_mfma_f32_16x16x16_bf16 v[36:39], v[94:95], v[46:47], v[36:39]
  v_mfma_f32_16x16x16_bf16 v[40:43], v[110:111], v[46:47], v[40:43]
  v_mfma_f32_16x16x16_bf16 v[36:39], v[96:97], v[48:49], v[36:39]
  v_mfma_f32_16x16x16_bf16 v[40:43], v[112:113], v[48:49], v[40:43]
  v_mfma_f32_16x16x16_bf16 v[36:39], v[98:99], v[50:51], v[36:39]
  v_mfma_f32_16x16x16_bf16 v[40:43], v[114:115], v[50:51], v[40:43]
  v_mfma_f32_16x16x16_bf16 v[36:39], v[100:101], v[52:53], v[36:39]
  v_mfma_f32_16x16x16_bf16 v[40:43], v[116:117], v[52:53], v[40:43]
  v_mfma_f32_16x16x16_bf16 v[36:39], v[102:103], v[54:55], v[36:39]
  v_mfma_f32_16x16x16_bf16 v[40:43], v[118:119], v[54:55], v[40:43]
  v_mfma_f32_16x16x16_bf16 v[36:39], v[104:105], v[56:57], v[36:39]
  v_mfma_f32_16x16x16_bf16 v[40:43], v[120:121], v[56:57], v[40:43]
  v_mfma_f32_16x16x16_bf16 v[36:39], v[106:107], v[58:59], v[36:39]
  v_mfma_f32_16x16x16_bf16 v[40:43], v[122:123], v[58:59], v[40:43]
  s_add_u32 s40, s64, 458752
  s_add_u32 s41, s40, 4096
  ds_read_b64_tr_b16 v[92:93], v10 offset:16384
  ds_read_b64_tr_b16 v[94:95], v11 offset:16384
  ds_read_b64_tr_b16 v[96:97], v12 offset:16384
  ds_read_b64_tr_b16 v[98:99], v13 offset:16384
  ds_read_b64_tr_b16 v[100:101], v14 offset:16384
  ds_read_b64_tr_b16 v[102:103], v15 offset:16384
  ds_read_b64_tr_b16 v[104:105], v16 offset:16384
  ds_read_b64_tr_b16 v[106:107], v17 offset:16384
  ds_read_b64_tr_b16 v[108:109], v10 offset:16640
  ds_read_b64_tr_b16 v[110:111], v11 offset:16640
  ds_read_b64_tr_b16 v[112:113], v12 offset:16640
  ds_read_b64_tr_b16 v[114:115], v13 offset:16640
  ds_read_b64_tr_b16 v[116:117], v14 offset:16640
  ds_read_b64_tr_b16 v[118:119], v15 offset:16640
  ds_read_b64_tr_b16 v[120:121], v16 offset:16640
  ds_read_b64_tr_b16 v[122:123], v17 offset:16640
  v_fma_f32 v164, v164, s96, -v18
  v_fma_f32 v165, v165, s96, -v18
  v_fma_f32 v166, v166, s96, -v18
  v_fma_f32 v167, v167, s96, -v18
  v_exp_f32 v164, v164
  v_exp_f32 v165, v165
  v_exp_f32 v166, v166
  v_exp_f32 v167, v167
  s_nop 0
  v_add_f32 v24, v164, v165
  v_add_f32 v25, v166, v167
  v_cvt_pk_bf16_f32 v164, v164, v165
  v_cvt_pk_bf16_f32 v165, v166, v167
  v_add_f32 v24, v24, v25
  v_add_f32 v19, v19, v24
  v_cndmask_b32 v44, 0, v164, s[48:49]
  v_cndmask_b32 v45, 0, v165, s[48:49]
  v_cndmask_b32 v46, 0, v164, s[50:51]
  v_cndmask_b32 v47, 0, v165, s[50:51]
  v_cndmask_b32 v48, 0, v164, s[52:53]
  v_cndmask_b32 v49, 0, v165, s[52:53]
  v_cndmask_b32 v50, 0, v164, s[54:55]
  v_cndmask_b32 v51, 0, v165, s[54:55]
  v_cndmask_b32 v52, 0, v164, s[56:57]
  v_cndmask_b32 v53, 0, v165, s[56:57]
  v_cndmask_b32 v54, 0, v164, s[58:59]
  v_cndmask_b32 v55, 0, v165, s[58:59]
  v_cndmask_b32 v56, 0, v164, s[60:61]
  v_cndmask_b32 v57, 0, v165, s[60:61]
  v_cndmask_b32 v58, 0, v164, s[62:63]
  v_cndmask_b32 v59, 0, v165, s[62:63]
  s_waitcnt lgkmcnt(0)
  s_waitcnt vmcnt(0)
  s_add_u32 m0, s42, 16384
  s_nop 0
  buffer_load_dwordx4 v2, s[28:31], s40 offen offset:0 nt lds
  buffer_load_dwordx4 v3, s[28:31], s40 offen offset:1024 nt lds
  buffer_load_dwordx4 v4, s[28:31], s40 offen offset:2048 nt lds
  buffer_load_dwordx4 v5, s[28:31], s40 offen offset:3072 nt lds
  s_add_u32 m0, s42, 20480
  s_nop 0
  buffer_load_dwordx4 v2, s[28:31], s41 offen offset:0 nt lds
  buffer_load_dwordx4 v3, s[28:31], s41 offen offset:1024 nt lds
  buffer_load_dwordx4 v4, s[28:31], s41 offen offset:2048 nt lds
  buffer_load_dwordx4 v5, s[28:31], s41 offen offset:3072 nt lds
  v_mfma_f32_16x16x16_bf16 v[36:39], v[92:93], v[44:45], v[36:39]
  v_mfma_f32_16x16x16_bf16 v[40:43], v[108:109], v[44:45], v[40:43]
  v_mfma_f32_16x16x16_bf16 v[36:39], v[94:95], v[46:47], v[36:39]
  v_mfma_f32_16x16x16_bf16 v[40:43], v[110:111], v[46:47], v[40:43]
  v_mfma_f32_16x16x16_bf16 v[36:39], v[96:97], v[48:49], v[36:39]
  v_mfma_f32_16x16x16_bf16 v[40:43], v[112:113], v[48:49], v[40:43]
  v_mfma_f32_16x16x16_bf16 v[36:39], v[98:99], v[50:51], v[36:39]
  v_mfma_f32_16x16x16_bf16 v[40:43], v[114:115], v[50:51], v[40:43]
  v_mfma_f32_16x16x16_bf16 v[36:39], v[100:101], v[52:53], v[36:39]
  v_mfma_f32_16x16x16_bf16 v[40:43], v[116:117], v[52:53], v[40:43]
  v_mfma_f32_16x16x16_bf16 v[36:39], v[102:103], v[54:55], v[36:39]
  v_mfma_f32_16x16x16_bf16 v[40:43], v[118:119], v[54:55], v[40:43]
  v_mfma_f32_16x16x16_bf16 v[36:39], v[104:105], v[56:57], v[36:39]
  v_mfma_f32_16x16x16_bf16 v[40:43], v[120:121], v[56:57], v[40:43]
  v_mfma_f32_16x16x16_bf16 v[36:39], v[106:107], v[58:59], v[36:39]
  v_mfma_f32_16x16x16_bf16 v[40:43], v[122:123], v[58:59], v[40:43]
  s_add_u32 s40, s64, 491520
  s_add_u32 s41, s40, 4096
  ds_read_b64_tr_b16 v[92:93], v10 offset:24576
  ds_read_b64_tr_b16 v[94:95], v11 offset:24576
  ds_read_b64_tr_b16 v[96:97], v12 offset:24576
  ds_read_b64_tr_b16 v[98:99], v13 offset:24576
  ds_read_b64_tr_b16 v[100:101], v14 offset:24576
  ds_read_b64_tr_b16 v[102:103], v15 offset:24576
  ds_read_b64_tr_b16 v[104:105], v16 offset:24576
  ds_read_b64_tr_b16 v[106:107], v17 offset:24576
  ds_read_b64_tr_b16 v[108:109], v10 offset:24832
  ds_read_b64_tr_b16 v[110:111], v11 offset:24832
  ds_read_b64_tr_b16 v[112:113], v12 offset:24832
  ds_read_b64_tr_b16 v[114:115], v13 offset:24832
  ds_read_b64_tr_b16 v[116:117], v14 offset:24832
  ds_read_b64_tr_b16 v[118:119], v15 offset:24832
  ds_read_b64_tr_b16 v[120:121], v16 offset:24832
  ds_read_b64_tr_b16 v[122:123], v17 offset:24832
  v_fma_f32 v168, v168, s96, -v18
  v_fma_f32 v169, v169, s96, -v18
  v_fma_f32 v170, v170, s96, -v18
  v_fma_f32 v171, v171, s96, -v18
  v_exp_f32 v168, v168
  v_exp_f32 v169, v169
  v_exp_f32 v170, v170
  v_exp_f32 v171, v171
  s_nop 0
  v_add_f32 v24, v168, v169
  v_add_f32 v25, v170, v171
  v_cvt_pk_bf16_f32 v168, v168, v169
  v_cvt_pk_bf16_f32 v169, v170, v171
  v_add_f32 v24, v24, v25
  v_add_f32 v19, v19, v24
  v_cndmask_b32 v44, 0, v168, s[48:49]
  v_cndmask_b32 v45, 0, v169, s[48:49]
  v_cndmask_b32 v46, 0, v168, s[50:51]
  v_cndmask_b32 v47, 0, v169, s[50:51]
  v_cndmask_b32 v48, 0, v168, s[52:53]
  v_cndmask_b32 v49, 0, v169, s[52:53]
  v_cndmask_b32 v50, 0, v168, s[54:55]
  v_cndmask_b32 v51, 0, v169, s[54:55]
  v_cndmask_b32 v52, 0, v168, s[56:57]
  v_cndmask_b32 v53, 0, v169, s[56:57]
  v_cndmask_b32 v54, 0, v168, s[58:59]
  v_cndmask_b32 v55, 0, v169, s[58:59]
  v_cndmask_b32 v56, 0, v168, s[60:61]
  v_cndmask_b32 v57, 0, v169, s[60:61]
  v_cndmask_b32 v58, 0, v168, s[62:63]
  v_cndmask_b32 v59, 0, v169, s[62:63]
  s_waitcnt lgkmcnt(0)
  s_waitcnt vmcnt(0)
  s_add_u32 m0, s42, 24576
  s_nop 0
  buffer_load_dwordx4 v2, s[28:31], s40 offen offset:0 nt lds
  buffer_load_dwordx4 v3, s[28:31], s40 offen offset:1024 nt lds
  buffer_load_dwordx4 v4, s[28:31], s40 offen offset:2048 nt lds
  buffer_load_dwordx4 v5, s[28:31], s40 offen offset:3072 nt lds
  s_add_u32 m0, s42, 28672
  s_nop 0
  buffer_load_dwordx4 v2, s[28:31], s41 offen offset:0 nt lds
  buffer_load_dwordx4 v3, s[28:31], s41 offen offset:1024 nt lds
  buffer_load_dwordx4 v4, s[28:31], s41 offen offset:2048 nt lds
  buffer_load_dwordx4 v5, s[28:31], s41 offen offset:3072 nt lds
  v_mfma_f32_16x16x16_bf16 v[36:39], v[92:93], v[44:45], v[36:39]
  v_mfma_f32_16x16x16_bf16 v[40:43], v[108:109], v[44:45], v[40:43]
  v_mfma_f32_16x16x16_bf16 v[36:39], v[94:95], v[46:47], v[36:39]
  v_mfma_f32_16x16x16_bf16 v[40:43], v[110:111], v[46:47], v[40:43]
  v_mfma_f32_16x16x16_bf16 v[36:39], v[96:97], v[48:49], v[36:39]
  v_mfma_f32_16x16x16_bf16 v[40:43], v[112:113], v[48:49], v[40:43]
  v_mfma_f32_16x16x16_bf16 v[36:39], v[98:99], v[50:51], v[36:39]
  v_mfma_f32_16x16x16_bf16 v[40:43], v[114:115], v[50:51], v[40:43]
  v_mfma_f32_16x16x16_bf16 v[36:39], v[100:101], v[52:53], v[36:39]
  v_mfma_f32_16x16x16_bf16 v[40:43], v[116:117], v[52:53], v[40:43]
  v_mfma_f32_16x16x16_bf16 v[36:39], v[102:103], v[54:55], v[36:39]
  v_mfma_f32_16x16x16_bf16 v[40:43], v[118:119], v[54:55], v[40:43]
  v_mfma_f32_16x16x16_bf16 v[36:39], v[104:105], v[56:57], v[36:39]
  v_mfma_f32_16x16x16_bf16 v[40:43], v[120:121], v[56:57], v[40:43]
  v_mfma_f32_16x16x16_bf16 v[36:39], v[106:107], v[58:59], v[36:39]
  v_mfma_f32_16x16x16_bf16 v[40:43], v[122:123], v[58:59], v[40:43]
  s_add_u32 s40, s64, 524288
  s_add_u32 s41, s40, 4096
  ds_read_b64_tr_b16 v[92:93], v10 offset:0
  ds_read_b64_tr_b16 v[94:95], v11 offset:0
  ds_read_b64_tr_b16 v[96:97], v12 offset:0
  ds_read_b64_tr_b16 v[98:99], v13 offset:0
  ds_read_b64_tr_b16 v[100:101], v14 offset:0
  ds_read_b64_tr_b16 v[102:103], v15 offset:0
  ds_read_b64_tr_b16 v[104:105], v16 offset:0
  ds_read_b64_tr_b16 v[106:107], v17 offset:0
  ds_read_b64_tr_b16 v[108:109], v10 offset:256
  ds_read_b64_tr_b16 v[110:111], v11 offset:256
  ds_read_b64_tr_b16 v[112:113], v12 offset:256
  ds_read_b64_tr_b16 v[114:115], v13 offset:256
  ds_read_b64_tr_b16 v[116:117], v14 offset:256
  ds_read_b64_tr_b16 v[118:119], v15 offset:256
  ds_read_b64_tr_b16 v[120:121], v16 offset:256
  ds_read_b64_tr_b16 v[122:123], v17 offset:256
  v_fma_f32 v172, v172, s96, -v18
  v_fma_f32 v173, v173, s96, -v18
  v_fma_f32 v174, v174, s96, -v18
  v_fma_f32 v175, v175, s96, -v18
  v_exp_f32 v172, v172
  v_exp_f32 v173, v173
  v_exp_f32 v174, v174
  v_exp_f32 v175, v175
  s_nop 0
  v_add_f32 v24, v172, v173
  v_add_f32 v25, v174, v175
  v_cvt_pk_bf16_f32 v172, v172, v173
  v_cvt_pk_bf16_f32 v173, v174, v175
  v_add_f32 v24, v24, v25
  v_add_f32 v19, v19, v24
  v_cndmask_b32 v44, 0, v172, s[48:49]
  v_cndmask_b32 v45, 0, v173, s[48:49]
  v_cndmask_b32 v46, 0, v172, s[50:51]
  v_cndmask_b32 v47, 0, v173, s[50:51]
  v_cndmask_b32 v48, 0, v172, s[52:53]
  v_cndmask_b32 v49, 0, v173, s[52:53]
  v_cndmask_b32 v50, 0, v172, s[54:55]
  v_cndmask_b32 v51, 0, v173, s[54:55]
  v_cndmask_b32 v52, 0, v172, s[56:57]
  v_cndmask_b32 v53, 0, v173, s[56:57]
  v_cndmask_b32 v54, 0, v172, s[58:59]
  v_cndmask_b32 v55, 0, v173, s[58:59]
  v_cndmask_b32 v56, 0, v172, s[60:61]
  v_cndmask_b32 v57, 0, v173, s[60:61]
  v_cndmask_b32 v58, 0, v172, s[62:63]
  v_cndmask_b32 v59, 0, v173, s[62:63]
  s_waitcnt lgkmcnt(0)
  s_waitcnt vmcnt(0)
  s_add_u32 m0, s42, 0
  s_nop 0
  buffer_load_dwordx4 v2, s[28:31], s40 offen offset:0 nt lds
  buffer_load_dwordx4 v3, s[28:31], s40 offen offset:1024 nt lds
  buffer_load_dwordx4 v4, s[28:31], s40 offen offset:2048 nt lds
  buffer_load_dwordx4 v5, s[28:31], s40 offen offset:3072 nt lds
  s_add_u32 m0, s42, 4096
  s_nop 0
  buffer_load_dwordx4 v2, s[28:31], s41 offen offset:0 nt lds
  buffer_load_dwordx4 v3, s[28:31], s41 offen offset:1024 nt lds
  buffer_load_dwordx4 v4, s[28:31], s41 offen offset:2048 nt lds
  buffer_load_dwordx4 v5, s[28:31], s41 offen offset:3072 nt lds
  v_mfma_f32_16x16x16_bf16 v[36:39], v[92:93], v[44:45], v[36:39]
  v_mfma_f32_16x16x16_bf16 v[40:43], v[108:109], v[44:45], v[40:43]
  v_mfma_f32_16x16x16_bf16 v[36:39], v[94:95], v[46:47], v[36:39]
  v_mfma_f32_16x16x16_bf16 v[40:43], v[110:111], v[46:47], v[40:43]
  v_mfma_f32_16x16x16_bf16 v[36:39], v[96:97], v[48:49], v[36:39]
  v_mfma_f32_16x16x16_bf16 v[40:43], v[112:113], v[48:49], v[40:43]
  v_mfma_f32_16x16x16_bf16 v[36:39], v[98:99], v[50:51], v[36:39]
  v_mfma_f32_16x16x16_bf16 v[40:43], v[114:115], v[50:51], v[40:43]
  v_mfma_f32_16x16x16_bf16 v[36:39], v[100:101], v[52:53], v[36:39]
  v_mfma_f32_16x16x16_bf16 v[40:43], v[116:117], v[52:53], v[40:43]
  v_mfma_f32_16x16x16_bf16 v[36:39], v[102:103], v[54:55], v[36:39]
  v_mfma_f32_16x16x16_bf16 v[40:43], v[118:119], v[54:55], v[40:43]
  v_mfma_f32_16x16x16_bf16 v[36:39], v[104:105], v[56:57], v[36:39]
  v_mfma_f32_16x16x16_bf16 v[40:43], v[120:121], v[56:57], v[40:43]
  v_mfma_f32_16x16x16_bf16 v[36:39], v[106:107], v[58:59], v[36:39]
  v_mfma_f32_16x16x16_bf16 v[40:43], v[122:123], v[58:59], v[40:43]
  s_add_u32 s40, s64, 557056
  s_add_u32 s41, s40, 4096
  ds_read_b64_tr_b16 v[92:93], v10 offset:8192
  ds_read_b64_tr_b16 v[94:95], v11 offset:8192
  ds_read_b64_tr_b16 v[96:97], v12 offset:8192
  ds_read_b64_tr_b16 v[98:99], v13 offset:8192
  ds_read_b64_tr_b16 v[100:101], v14 offset:8192
  ds_read_b64_tr_b16 v[102:103], v15 offset:8192
  ds_read_b64_tr_b16 v[104:105], v16 offset:8192
  ds_read_b64_tr_b16 v[106:107], v17 offset:8192
  ds_read_b64_tr_b16 v[108:109], v10 offset:8448
  ds_read_b64_tr_b16 v[110:111], v11 offset:8448
  ds_read_b64_tr_b16 v[112:113], v12 offset:8448
  ds_read_b64_tr_b16 v[114:115], v13 offset:8448
  ds_read_b64_tr_b16 v[116:117], v14 offset:8448
  ds_read_b64_tr_b16 v[118:119], v15 offset:8448
  ds_read_b64_tr_b16 v[120:121], v16 offset:8448
  ds_read_b64_tr_b16 v[122:123], v17 offset:8448
  v_fma_f32 v176, v176, s96, -v18
  v_fma_f32 v177, v177, s96, -v18
  v_fma_f32 v178, v178, s96, -v18
  v_fma_f32 v179, v179, s96, -v18
  v_exp_f32 v176, v176
  v_exp_f32 v177, v177
  v_exp_f32 v178, v178
  v_exp_f32 v179, v179
  s_nop 0
  v_add_f32 v24, v176, v177
  v_add_f32 v25, v178, v179
  v_cvt_pk_bf16_f32 v176, v176, v177
  v_cvt_pk_bf16_f32 v177, v178, v179
  v_add_f32 v24, v24, v25
  v_add_f32 v19, v19, v24
  v_cndmask_b32 v44, 0, v176, s[48:49]
  v_cndmask_b32 v45, 0, v177, s[48:49]
  v_cndmask_b32 v46, 0, v176, s[50:51]
  v_cndmask_b32 v47, 0, v177, s[50:51]
  v_cndmask_b32 v48, 0, v176, s[52:53]
  v_cndmask_b32 v49, 0, v177, s[52:53]
  v_cndmask_b32 v50, 0, v176, s[54:55]
  v_cndmask_b32 v51, 0, v177, s[54:55]
  v_cndmask_b32 v52, 0, v176, s[56:57]
  v_cndmask_b32 v53, 0, v177, s[56:57]
  v_cndmask_b32 v54, 0, v176, s[58:59]
  v_cndmask_b32 v55, 0, v177, s[58:59]
  v_cndmask_b32 v56, 0, v176, s[60:61]
  v_cndmask_b32 v57, 0, v177, s[60:61]
  v_cndmask_b32 v58, 0, v176, s[62:63]
  v_cndmask_b32 v59, 0, v177, s[62:63]
  s_waitcnt lgkmcnt(0)
  s_waitcnt vmcnt(0)
  s_add_u32 m0, s42, 8192
  s_nop 0
  buffer_load_dwordx4 v2, s[28:31], s40 offen offset:0 nt lds
  buffer_load_dwordx4 v3, s[28:31], s40 offen offset:1024 nt lds
  buffer_load_dwordx4 v4, s[28:31], s40 offen offset:2048 nt lds
  buffer_load_dwordx4 v5, s[28:31], s40 offen offset:3072 nt lds
  s_add_u32 m0, s42, 12288
  s_nop 0
  buffer_load_dwordx4 v2, s[28:31], s41 offen offset:0 nt lds
  buffer_load_dwordx4 v3, s[28:31], s41 offen offset:1024 nt lds
  buffer_load_dwordx4 v4, s[28:31], s41 offen offset:2048 nt lds
  buffer_load_dwordx4 v5, s[28:31], s41 offen offset:3072 nt lds
  v_mfma_f32_16x16x16_bf16 v[36:39], v[92:93], v[44:45], v[36:39]
  v_mfma_f32_16x16x16_bf16 v[40:43], v[108:109], v[44:45], v[40:43]
  v_mfma_f32_16x16x16_bf16 v[36:39], v[94:95], v[46:47], v[36:39]
  v_mfma_f32_16x16x16_bf16 v[40:43], v[110:111], v[46:47], v[40:43]
  v_mfma_f32_16x16x16_bf16 v[36:39], v[96:97], v[48:49], v[36:39]
  v_mfma_f32_16x16x16_bf16 v[40:43], v[112:113], v[48:49], v[40:43]
  v_mfma_f32_16x16x16_bf16 v[36:39], v[98:99], v[50:51], v[36:39]
  v_mfma_f32_16x16x16_bf16 v[40:43], v[114:115], v[50:51], v[40:43]
  v_mfma_f32_16x16x16_bf16 v[36:39], v[100:101], v[52:53], v[36:39]
  v_mfma_f32_16x16x16_bf16 v[40:43], v[116:117], v[52:53], v[40:43]
  v_mfma_f32_16x16x16_bf16 v[36:39], v[102:103], v[54:55], v[36:39]
  v_mfma_f32_16x16x16_bf16 v[40:43], v[118:119], v[54:55], v[40:43]
  v_mfma_f32_16x16x16_bf16 v[36:39], v[104:105], v[56:57], v[36:39]
  v_mfma_f32_16x16x16_bf16 v[40:43], v[120:121], v[56:57], v[40:43]
  v_mfma_f32_16x16x16_bf16 v[36:39], v[106:107], v[58:59], v[36:39]
  v_mfma_f32_16x16x16_bf16 v[40:43], v[122:123], v[58:59], v[40:43]
  s_add_u32 s40, s64, 589824
  s_add_u32 s41, s40, 4096
  ds_read_b64_tr_b16 v[92:93], v10 offset:16384
  ds_read_b64_tr_b16 v[94:95], v11 offset:16384
  ds_read_b64_tr_b16 v[96:97], v12 offset:16384
  ds_read_b64_tr_b16 v[98:99], v13 offset:16384
  ds_read_b64_tr_b16 v[100:101], v14 offset:16384
  ds_read_b64_tr_b16 v[102:103], v15 offset:16384
  ds_read_b64_tr_b16 v[104:105], v16 offset:16384
  ds_read_b64_tr_b16 v[106:107], v17 offset:16384
  ds_read_b64_tr_b16 v[108:109], v10 offset:16640
  ds_read_b64_tr_b16 v[110:111], v11 offset:16640
  ds_read_b64_tr_b16 v[112:113], v12 offset:16640
  ds_read_b64_tr_b16 v[114:115], v13 offset:16640
  ds_read_b64_tr_b16 v[116:117], v14 offset:16640
  ds_read_b64_tr_b16 v[118:119], v15 offset:16640
  ds_read_b64_tr_b16 v[120:121], v16 offset:16640
  ds_read_b64_tr_b16 v[122:123], v17 offset:16640
  v_fma_f32 v180, v180, s96, -v18
  v_fma_f32 v181, v181, s96, -v18
  v_fma_f32 v182, v182, s96, -v18
  v_fma_f32 v183, v183, s96, -v18
  v_exp_f32 v180, v180
  v_exp_f32 v181, v181
  v_exp_f32 v182, v182
  v_exp_f32 v183, v183
  s_nop 0
  v_add_f32 v24, v180, v181
  v_add_f32 v25, v182, v183
  v_cvt_pk_bf16_f32 v180, v180, v181
  v_cvt_pk_bf16_f32 v181, v182, v183
  v_add_f32 v24, v24, v25
  v_add_f32 v19, v19, v24
  v_cndmask_b32 v44, 0, v180, s[48:49]
  v_cndmask_b32 v45, 0, v181, s[48:49]
  v_cndmask_b32 v46, 0, v180, s[50:51]
  v_cndmask_b32 v47, 0, v181, s[50:51]
  v_cndmask_b32 v48, 0, v180, s[52:53]
  v_cndmask_b32 v49, 0, v181, s[52:53]
  v_cndmask_b32 v50, 0, v180, s[54:55]
  v_cndmask_b32 v51, 0, v181, s[54:55]
  v_cndmask_b32 v52, 0, v180, s[56:57]
  v_cndmask_b32 v53, 0, v181, s[56:57]
  v_cndmask_b32 v54, 0, v180, s[58:59]
  v_cndmask_b32 v55, 0, v181, s[58:59]
  v_cndmask_b32 v56, 0, v180, s[60:61]
  v_cndmask_b32 v57, 0, v181, s[60:61]
  v_cndmask_b32 v58, 0, v180, s[62:63]
  v_cndmask_b32 v59, 0, v181, s[62:63]
  s_waitcnt lgkmcnt(0)
  s_waitcnt vmcnt(0)
  s_add_u32 m0, s42, 16384
  s_nop 0
  buffer_load_dwordx4 v2, s[28:31], s40 offen offset:0 nt lds
  buffer_load_dwordx4 v3, s[28:31], s40 offen offset:1024 nt lds
  buffer_load_dwordx4 v4, s[28:31], s40 offen offset:2048 nt lds
  buffer_load_dwordx4 v5, s[28:31], s40 offen offset:3072 nt lds
  s_add_u32 m0, s42, 20480
  s_nop 0
  buffer_load_dwordx4 v2, s[28:31], s41 offen offset:0 nt lds
  buffer_load_dwordx4 v3, s[28:31], s41 offen offset:1024 nt lds
  buffer_load_dwordx4 v4, s[28:31], s41 offen offset:2048 nt lds
  buffer_load_dwordx4 v5, s[28:31], s41 offen offset:3072 nt lds
  v_mfma_f32_16x16x16_bf16 v[36:39], v[92:93], v[44:45], v[36:39]
  v_mfma_f32_16x16x16_bf16 v[40:43], v[108:109], v[44:45], v[40:43]
  v_mfma_f32_16x16x16_bf16 v[36:39], v[94:95], v[46:47], v[36:39]
  v_mfma_f32_16x16x16_bf16 v[40:43], v[110:111], v[46:47], v[40:43]
  v_mfma_f32_16x16x16_bf16 v[36:39], v[96:97], v[48:49], v[36:39]
  v_mfma_f32_16x16x16_bf16 v[40:43], v[112:113], v[48:49], v[40:43]
  v_mfma_f32_16x16x16_bf16 v[36:39], v[98:99], v[50:51], v[36:39]
  v_mfma_f32_16x16x16_bf16 v[40:43], v[114:115], v[50:51], v[40:43]
  v_mfma_f32_16x16x16_bf16 v[36:39], v[100:101], v[52:53], v[36:39]
  v_mfma_f32_16x16x16_bf16 v[40:43], v[116:117], v[52:53], v[40:43]
  v_mfma_f32_16x16x16_bf16 v[36:39], v[102:103], v[54:55], v[36:39]
  v_mfma_f32_16x16x16_bf16 v[40:43], v[118:119], v[54:55], v[40:43]
  v_mfma_f32_16x16x16_bf16 v[36:39], v[104:105], v[56:57], v[36:39]
  v_mfma_f32_16x16x16_bf16 v[40:43], v[120:121], v[56:57], v[40:43]
  v_mfma_f32_16x16x16_bf16 v[36:39], v[106:107], v[58:59], v[36:39]
  v_mfma_f32_16x16x16_bf16 v[40:43], v[122:123], v[58:59], v[40:43]
  s_add_u32 s40, s64, 622592
  s_add_u32 s41, s40, 4096
  ds_read_b64_tr_b16 v[92:93], v10 offset:24576
  ds_read_b64_tr_b16 v[94:95], v11 offset:24576
  ds_read_b64_tr_b16 v[96:97], v12 offset:24576
  ds_read_b64_tr_b16 v[98:99], v13 offset:24576
  ds_read_b64_tr_b16 v[100:101], v14 offset:24576
  ds_read_b64_tr_b16 v[102:103], v15 offset:24576
  ds_read_b64_tr_b16 v[104:105], v16 offset:24576
  ds_read_b64_tr_b16 v[106:107], v17 offset:24576
  ds_read_b64_tr_b16 v[108:109], v10 offset:24832
  ds_read_b64_tr_b16 v[110:111], v11 offset:24832
  ds_read_b64_tr_b16 v[112:113], v12 offset:24832
  ds_read_b64_tr_b16 v[114:115], v13 offset:24832
  ds_read_b64_tr_b16 v[116:117], v14 offset:24832
  ds_read_b64_tr_b16 v[118:119], v15 offset:24832
  ds_read_b64_tr_b16 v[120:121], v16 offset:24832
  ds_read_b64_tr_b16 v[122:123], v17 offset:24832
  v_fma_f32 v184, v184, s96, -v18
  v_fma_f32 v185, v185, s96, -v18
  v_fma_f32 v186, v186, s96, -v18
  v_fma_f32 v187, v187, s96, -v18
  v_exp_f32 v184, v184
  v_exp_f32 v185, v185
  v_exp_f32 v186, v186
  v_exp_f32 v187, v187
  s_nop 0
  v_add_f32 v24, v184, v185
  v_add_f32 v25, v186, v187
  v_cvt_pk_bf16_f32 v184, v184, v185
  v_cvt_pk_bf16_f32 v185, v186, v187
  v_add_f32 v24, v24, v25
  v_add_f32 v19, v19, v24
  v_cndmask_b32 v44, 0, v184, s[48:49]
  v_cndmask_b32 v45, 0, v185, s[48:49]
  v_cndmask_b32 v46, 0, v184, s[50:51]
  v_cndmask_b32 v47, 0, v185, s[50:51]
  v_cndmask_b32 v48, 0, v184, s[52:53]
  v_cndmask_b32 v49, 0, v185, s[52:53]
  v_cndmask_b32 v50, 0, v184, s[54:55]
  v_cndmask_b32 v51, 0, v185, s[54:55]
  v_cndmask_b32 v52, 0, v184, s[56:57]
  v_cndmask_b32 v53, 0, v185, s[56:57]
  v_cndmask_b32 v54, 0, v184, s[58:59]
  v_cndmask_b32 v55, 0, v185, s[58:59]
  v_cndmask_b32 v56, 0, v184, s[60:61]
  v_cndmask_b32 v57, 0, v185, s[60:61]
  v_cndmask_b32 v58, 0, v184, s[62:63]
  v_cndmask_b32 v59, 0, v185, s[62:63]
  s_waitcnt lgkmcnt(0)
  s_waitcnt vmcnt(0)
  s_add_u32 m0, s42, 24576
  s_nop 0
  buffer_load_dwordx4 v2, s[28:31], s40 offen offset:0 nt lds
  buffer_load_dwordx4 v3, s[28:31], s40 offen offset:1024 nt lds
  buffer_load_dwordx4 v4, s[28:31], s40 offen offset:2048 nt lds
  buffer_load_dwordx4 v5, s[28:31], s40 offen offset:3072 nt lds
  s_add_u32 m0, s42, 28672
  s_nop 0
  buffer_load_dwordx4 v2, s[28:31], s41 offen offset:0 nt lds
  buffer_load_dwordx4 v3, s[28:31], s41 offen offset:1024 nt lds
  buffer_load_dwordx4 v4, s[28:31], s41 offen offset:2048 nt lds
  buffer_load_dwordx4 v5, s[28:31], s41 offen offset:3072 nt lds
  v_mfma_f32_16x16x16_bf16 v[36:39], v[92:93], v[44:45], v[36:39]
  v_mfma_f32_16x16x16_bf16 v[40:43], v[108:109], v[44:45], v[40:43]
  v_mfma_f32_16x16x16_bf16 v[36:39], v[94:95], v[46:47], v[36:39]
  v_mfma_f32_16x16x16_bf16 v[40:43], v[110:111], v[46:47], v[40:43]
  v_mfma_f32_16x16x16_bf16 v[36:39], v[96:97], v[48:49], v[36:39]
  v_mfma_f32_16x16x16_bf16 v[40:43], v[112:113], v[48:49], v[40:43]
  v_mfma_f32_16x16x16_bf16 v[36:39], v[98:99], v[50:51], v[36:39]
  v_mfma_f32_16x16x16_bf16 v[40:43], v[114:115], v[50:51], v[40:43]
  v_mfma_f32_16x16x16_bf16 v[36:39], v[100:101], v[52:53], v[36:39]
  v_mfma_f32_16x16x16_bf16 v[40:43], v[116:117], v[52:53], v[40:43]
  v_mfma_f32_16x16x16_bf16 v[36:39], v[102:103], v[54:55], v[36:39]
  v_mfma_f32_16x16x16_bf16 v[40:43], v[118:119], v[54:55], v[40:43]
  v_mfma_f32_16x16x16_bf16 v[36:39], v[104:105], v[56:57], v[36:39]
  v_mfma_f32_16x16x16_bf16 v[40:43], v[120:121], v[56:57], v[40:43]
  v_mfma_f32_16x16x16_bf16 v[36:39], v[106:107], v[58:59], v[36:39]
  v_mfma_f32_16x16x16_bf16 v[40:43], v[122:123], v[58:59], v[40:43]
  s_add_u32 s40, s64, 655360
  s_add_u32 s41, s40, 4096
  ds_read_b64_tr_b16 v[92:93], v10 offset:0
  ds_read_b64_tr_b16 v[94:95], v11 offset:0
  ds_read_b64_tr_b16 v[96:97], v12 offset:0
  ds_read_b64_tr_b16 v[98:99], v13 offset:0
  ds_read_b64_tr_b16 v[100:101], v14 offset:0
  ds_read_b64_tr_b16 v[102:103], v15 offset:0
  ds_read_b64_tr_b16 v[104:105], v16 offset:0
  ds_read_b64_tr_b16 v[106:107], v17 offset:0
  ds_read_b64_tr_b16 v[108:109], v10 offset:256
  ds_read_b64_tr_b16 v[110:111], v11 offset:256
  ds_read_b64_tr_b16 v[112:113], v12 offset:256
  ds_read_b64_tr_b16 v[114:115], v13 offset:256
  ds_read_b64_tr_b16 v[116:117], v14 offset:256
  ds_read_b64_tr_b16 v[118:119], v15 offset:256
  ds_read_b64_tr_b16 v[120:121], v16 offset:256
  ds_read_b64_tr_b16 v[122:123], v17 offset:256
  v_fma_f32 v188, v188, s96, -v18
  v_fma_f32 v189, v189, s96, -v18
  v_fma_f32 v190, v190, s96, -v18
  v_fma_f32 v191, v191, s96, -v18
  v_exp_f32 v188, v188
  v_exp_f32 v189, v189
  v_exp_f32 v190, v190
  v_exp_f32 v191, v191
  s_nop 0
  v_add_f32 v24, v188, v189
  v_add_f32 v25, v190, v191
  v_cvt_pk_bf16_f32 v188, v188, v189
  v_cvt_pk_bf16_f32 v189, v190, v191
  v_add_f32 v24, v24, v25
  v_add_f32 v19, v19, v24
  v_cndmask_b32 v44, 0, v188, s[48:49]
  v_cndmask_b32 v45, 0, v189, s[48:49]
  v_cndmask_b32 v46, 0, v188, s[50:51]
  v_cndmask_b32 v47, 0, v189, s[50:51]
  v_cndmask_b32 v48, 0, v188, s[52:53]
  v_cndmask_b32 v49, 0, v189, s[52:53]
  v_cndmask_b32 v50, 0, v188, s[54:55]
  v_cndmask_b32 v51, 0, v189, s[54:55]
  v_cndmask_b32 v52, 0, v188, s[56:57]
  v_cndmask_b32 v53, 0, v189, s[56:57]
  v_cndmask_b32 v54, 0, v188, s[58:59]
  v_cndmask_b32 v55, 0, v189, s[58:59]
  v_cndmask_b32 v56, 0, v188, s[60:61]
  v_cndmask_b32 v57, 0, v189, s[60:61]
  v_cndmask_b32 v58, 0, v188, s[62:63]
  v_cndmask_b32 v59, 0, v189, s[62:63]
  s_waitcnt lgkmcnt(0)
  s_waitcnt vmcnt(0)
  s_add_u32 m0, s42, 0
  s_nop 0
  buffer_load_dwordx4 v2, s[28:31], s40 offen offset:0 nt lds
  buffer_load_dwordx4 v3, s[28:31], s40 offen offset:1024 nt lds
  buffer_load_dwordx4 v4, s[28:31], s40 offen offset:2048 nt lds
  buffer_load_dwordx4 v5, s[28:31], s40 offen offset:3072 nt lds
  s_add_u32 m0, s42, 4096
  s_nop 0
  buffer_load_dwordx4 v2, s[28:31], s41 offen offset:0 nt lds
  buffer_load_dwordx4 v3, s[28:31], s41 offen offset:1024 nt lds
  buffer_load_dwordx4 v4, s[28:31], s41 offen offset:2048 nt lds
  buffer_load_dwordx4 v5, s[28:31], s41 offen offset:3072 nt lds
  v_mfma_f32_16x16x16_bf16 v[36:39], v[92:93], v[44:45], v[36:39]
  v_mfma_f32_16x16x16_bf16 v[40:43], v[108:109], v[44:45], v[40:43]
  v_mfma_f32_16x16x16_bf16 v[36:39], v[94:95], v[46:47], v[36:39]
  v_mfma_f32_16x16x16_bf16 v[40:43], v[110:111], v[46:47], v[40:43]
  v_mfma_f32_16x16x16_bf16 v[36:39], v[96:97], v[48:49], v[36:39]
  v_mfma_f32_16x16x16_bf16 v[40:43], v[112:113], v[48:49], v[40:43]
  v_mfma_f32_16x16x16_bf16 v[36:39], v[98:99], v[50:51], v[36:39]
  v_mfma_f32_16x16x16_bf16 v[40:43], v[114:115], v[50:51], v[40:43]
  v_mfma_f32_16x16x16_bf16 v[36:39], v[100:101], v[52:53], v[36:39]
  v_mfma_f32_16x16x16_bf16 v[40:43], v[116:117], v[52:53], v[40:43]
  v_mfma_f32_16x16x16_bf16 v[36:39], v[102:103], v[54:55], v[36:39]
  v_mfma_f32_16x16x16_bf16 v[40:43], v[118:119], v[54:55], v[40:43]
  v_mfma_f32_16x16x16_bf16 v[36:39], v[104:105], v[56:57], v[36:39]
  v_mfma_f32_16x16x16_bf16 v[40:43], v[120:121], v[56:57], v[40:43]
  v_mfma_f32_16x16x16_bf16 v[36:39], v[106:107], v[58:59], v[36:39]
  v_mfma_f32_16x16x16_bf16 v[40:43], v[122:123], v[58:59], v[40:43]
  s_add_u32 s40, s64, 688128
  s_add_u32 s41, s40, 4096
  ds_read_b64_tr_b16 v[92:93], v10 offset:8192
  ds_read_b64_tr_b16 v[94:95], v11 offset:8192
  ds_read_b64_tr_b16 v[96:97], v12 offset:8192
  ds_read_b64_tr_b16 v[98:99], v13 offset:8192
  ds_read_b64_tr_b16 v[100:101], v14 offset:8192
  ds_read_b64_tr_b16 v[102:103], v15 offset:8192
  ds_read_b64_tr_b16 v[104:105], v16 offset:8192
  ds_read_b64_tr_b16 v[106:107], v17 offset:8192
  ds_read_b64_tr_b16 v[108:109], v10 offset:8448
  ds_read_b64_tr_b16 v[110:111], v11 offset:8448
  ds_read_b64_tr_b16 v[112:113], v12 offset:8448
  ds_read_b64_tr_b16 v[114:115], v13 offset:8448
  ds_read_b64_tr_b16 v[116:117], v14 offset:8448
  ds_read_b64_tr_b16 v[118:119], v15 offset:8448
  ds_read_b64_tr_b16 v[120:121], v16 offset:8448
  ds_read_b64_tr_b16 v[122:123], v17 offset:8448
  v_fma_f32 v192, v192, s96, -v18
  v_fma_f32 v193, v193, s96, -v18
  v_fma_f32 v194, v194, s96, -v18
  v_fma_f32 v195, v195, s96, -v18
  v_exp_f32 v192, v192
  v_exp_f32 v193, v193
  v_exp_f32 v194, v194
  v_exp_f32 v195, v195
  s_nop 0
  v_add_f32 v24, v192, v193
  v_add_f32 v25, v194, v195
  v_cvt_pk_bf16_f32 v192, v192, v193
  v_cvt_pk_bf16_f32 v193, v194, v195
  v_add_f32 v24, v24, v25
  v_add_f32 v19, v19, v24
  v_cndmask_b32 v44, 0, v192, s[48:49]
  v_cndmask_b32 v45, 0, v193, s[48:49]
  v_cndmask_b32 v46, 0, v192, s[50:51]
  v_cndmask_b32 v47, 0, v193, s[50:51]
  v_cndmask_b32 v48, 0, v192, s[52:53]
  v_cndmask_b32 v49, 0, v193, s[52:53]
  v_cndmask_b32 v50, 0, v192, s[54:55]
  v_cndmask_b32 v51, 0, v193, s[54:55]
  v_cndmask_b32 v52, 0, v192, s[56:57]
  v_cndmask_b32 v53, 0, v193, s[56:57]
  v_cndmask_b32 v54, 0, v192, s[58:59]
  v_cndmask_b32 v55, 0, v193, s[58:59]
  v_cndmask_b32 v56, 0, v192, s[60:61]
  v_cndmask_b32 v57, 0, v193, s[60:61]
  v_cndmask_b32 v58, 0, v192, s[62:63]
  v_cndmask_b32 v59, 0, v193, s[62:63]
  s_waitcnt lgkmcnt(0)
  s_waitcnt vmcnt(0)
  s_add_u32 m0, s42, 8192
  s_nop 0
  buffer_load_dwordx4 v2, s[28:31], s40 offen offset:0 nt lds
  buffer_load_dwordx4 v3, s[28:31], s40 offen offset:1024 nt lds
  buffer_load_dwordx4 v4, s[28:31], s40 offen offset:2048 nt lds
  buffer_load_dwordx4 v5, s[28:31], s40 offen offset:3072 nt lds
  s_add_u32 m0, s42, 12288
  s_nop 0
  buffer_load_dwordx4 v2, s[28:31], s41 offen offset:0 nt lds
  buffer_load_dwordx4 v3, s[28:31], s41 offen offset:1024 nt lds
  buffer_load_dwordx4 v4, s[28:31], s41 offen offset:2048 nt lds
  buffer_load_dwordx4 v5, s[28:31], s41 offen offset:3072 nt lds
  v_mfma_f32_16x16x16_bf16 v[36:39], v[92:93], v[44:45], v[36:39]
  v_mfma_f32_16x16x16_bf16 v[40:43], v[108:109], v[44:45], v[40:43]
  v_mfma_f32_16x16x16_bf16 v[36:39], v[94:95], v[46:47], v[36:39]
  v_mfma_f32_16x16x16_bf16 v[40:43], v[110:111], v[46:47], v[40:43]
  v_mfma_f32_16x16x16_bf16 v[36:39], v[96:97], v[48:49], v[36:39]
  v_mfma_f32_16x16x16_bf16 v[40:43], v[112:113], v[48:49], v[40:43]
  v_mfma_f32_16x16x16_bf16 v[36:39], v[98:99], v[50:51], v[36:39]
  v_mfma_f32_16x16x16_bf16 v[40:43], v[114:115], v[50:51], v[40:43]
  v_mfma_f32_16x16x16_bf16 v[36:39], v[100:101], v[52:53], v[36:39]
  v_mfma_f32_16x16x16_bf16 v[40:43], v[116:117], v[52:53], v[40:43]
  v_mfma_f32_16x16x16_bf16 v[36:39], v[102:103], v[54:55], v[36:39]
  v_mfma_f32_16x16x16_bf16 v[40:43], v[118:119], v[54:55], v[40:43]
  v_mfma_f32_16x16x16_bf16 v[36:39], v[104:105], v[56:57], v[36:39]
  v_mfma_f32_16x16x16_bf16 v[40:43], v[120:121], v[56:57], v[40:43]
  v_mfma_f32_16x16x16_bf16 v[36:39], v[106:107], v[58:59], v[36:39]
  v_mfma_f32_16x16x16_bf16 v[40:43], v[122:123], v[58:59], v[40:43]
  s_add_u32 s40, s64, 720896
  s_add_u32 s41, s40, 4096
  ds_read_b64_tr_b16 v[92:93], v10 offset:16384
  ds_read_b64_tr_b16 v[94:95], v11 offset:16384
  ds_read_b64_tr_b16 v[96:97], v12 offset:16384
  ds_read_b64_tr_b16 v[98:99], v13 offset:16384
  ds_read_b64_tr_b16 v[100:101], v14 offset:16384
  ds_read_b64_tr_b16 v[102:103], v15 offset:16384
  ds_read_b64_tr_b16 v[104:105], v16 offset:16384
  ds_read_b64_tr_b16 v[106:107], v17 offset:16384
  ds_read_b64_tr_b16 v[108:109], v10 offset:16640
  ds_read_b64_tr_b16 v[110:111], v11 offset:16640
  ds_read_b64_tr_b16 v[112:113], v12 offset:16640
  ds_read_b64_tr_b16 v[114:115], v13 offset:16640
  ds_read_b64_tr_b16 v[116:117], v14 offset:16640
  ds_read_b64_tr_b16 v[118:119], v15 offset:16640
  ds_read_b64_tr_b16 v[120:121], v16 offset:16640
  ds_read_b64_tr_b16 v[122:123], v17 offset:16640
  v_fma_f32 v196, v196, s96, -v18
  v_fma_f32 v197, v197, s96, -v18
  v_fma_f32 v198, v198, s96, -v18
  v_fma_f32 v199, v199, s96, -v18
  v_exp_f32 v196, v196
  v_exp_f32 v197, v197
  v_exp_f32 v198, v198
  v_exp_f32 v199, v199
  s_nop 0
  v_add_f32 v24, v196, v197
  v_add_f32 v25, v198, v199
  v_cvt_pk_bf16_f32 v196, v196, v197
  v_cvt_pk_bf16_f32 v197, v198, v199
  v_add_f32 v24, v24, v25
  v_add_f32 v19, v19, v24
  v_cndmask_b32 v44, 0, v196, s[48:49]
  v_cndmask_b32 v45, 0, v197, s[48:49]
  v_cndmask_b32 v46, 0, v196, s[50:51]
  v_cndmask_b32 v47, 0, v197, s[50:51]
  v_cndmask_b32 v48, 0, v196, s[52:53]
  v_cndmask_b32 v49, 0, v197, s[52:53]
  v_cndmask_b32 v50, 0, v196, s[54:55]
  v_cndmask_b32 v51, 0, v197, s[54:55]
  v_cndmask_b32 v52, 0, v196, s[56:57]
  v_cndmask_b32 v53, 0, v197, s[56:57]
  v_cndmask_b32 v54, 0, v196, s[58:59]
  v_cndmask_b32 v55, 0, v197, s[58:59]
  v_cndmask_b32 v56, 0, v196, s[60:61]
  v_cndmask_b32 v57, 0, v197, s[60:61]
  v_cndmask_b32 v58, 0, v196, s[62:63]
  v_cndmask_b32 v59, 0, v197, s[62:63]
  s_waitcnt lgkmcnt(0)
  s_waitcnt vmcnt(0)
  s_add_u32 m0, s42, 16384
  s_nop 0
  buffer_load_dwordx4 v2, s[28:31], s40 offen offset:0 nt lds
  buffer_load_dwordx4 v3, s[28:31], s40 offen offset:1024 nt lds
  buffer_load_dwordx4 v4, s[28:31], s40 offen offset:2048 nt lds
  buffer_load_dwordx4 v5, s[28:31], s40 offen offset:3072 nt lds
  s_add_u32 m0, s42, 20480
  s_nop 0
  buffer_load_dwordx4 v2, s[28:31], s41 offen offset:0 nt lds
  buffer_load_dwordx4 v3, s[28:31], s41 offen offset:1024 nt lds
  buffer_load_dwordx4 v4, s[28:31], s41 offen offset:2048 nt lds
  buffer_load_dwordx4 v5, s[28:31], s41 offen offset:3072 nt lds
  v_mfma_f32_16x16x16_bf16 v[36:39], v[92:93], v[44:45], v[36:39]
  v_mfma_f32_16x16x16_bf16 v[40:43], v[108:109], v[44:45], v[40:43]
  v_mfma_f32_16x16x16_bf16 v[36:39], v[94:95], v[46:47], v[36:39]
  v_mfma_f32_16x16x16_bf16 v[40:43], v[110:111], v[46:47], v[40:43]
  v_mfma_f32_16x16x16_bf16 v[36:39], v[96:97], v[48:49], v[36:39]
  v_mfma_f32_16x16x16_bf16 v[40:43], v[112:113], v[48:49], v[40:43]
  v_mfma_f32_16x16x16_bf16 v[36:39], v[98:99], v[50:51], v[36:39]
  v_mfma_f32_16x16x16_bf16 v[40:43], v[114:115], v[50:51], v[40:43]
  v_mfma_f32_16x16x16_bf16 v[36:39], v[100:101], v[52:53], v[36:39]
  v_mfma_f32_16x16x16_bf16 v[40:43], v[116:117], v[52:53], v[40:43]
  v_mfma_f32_16x16x16_bf16 v[36:39], v[102:103], v[54:55], v[36:39]
  v_mfma_f32_16x16x16_bf16 v[40:43], v[118:119], v[54:55], v[40:43]
  v_mfma_f32_16x16x16_bf16 v[36:39], v[104:105], v[56:57], v[36:39]
  v_mfma_f32_16x16x16_bf16 v[40:43], v[120:121], v[56:57], v[40:43]
  v_mfma_f32_16x16x16_bf16 v[36:39], v[106:107], v[58:59], v[36:39]
  v_mfma_f32_16x16x16_bf16 v[40:43], v[122:123], v[58:59], v[40:43]
  s_add_u32 s40, s64, 753664
  s_add_u32 s41, s40, 4096
  ds_read_b64_tr_b16 v[92:93], v10 offset:24576
  ds_read_b64_tr_b16 v[94:95], v11 offset:24576
  ds_read_b64_tr_b16 v[96:97], v12 offset:24576
  ds_read_b64_tr_b16 v[98:99], v13 offset:24576
  ds_read_b64_tr_b16 v[100:101], v14 offset:24576
  ds_read_b64_tr_b16 v[102:103], v15 offset:24576
  ds_read_b64_tr_b16 v[104:105], v16 offset:24576
  ds_read_b64_tr_b16 v[106:107], v17 offset:24576
  ds_read_b64_tr_b16 v[108:109], v10 offset:24832
  ds_read_b64_tr_b16 v[110:111], v11 offset:24832
  ds_read_b64_tr_b16 v[112:113], v12 offset:24832
  ds_read_b64_tr_b16 v[114:115], v13 offset:24832
  ds_read_b64_tr_b16 v[116:117], v14 offset:24832
  ds_read_b64_tr_b16 v[118:119], v15 offset:24832
  ds_read_b64_tr_b16 v[120:121], v16 offset:24832
  ds_read_b64_tr_b16 v[122:123], v17 offset:24832
  v_fma_f32 v200, v200, s96, -v18
  v_fma_f32 v201, v201, s96, -v18
  v_fma_f32 v202, v202, s96, -v18
  v_fma_f32 v203, v203, s96, -v18
  v_exp_f32 v200, v200
  v_exp_f32 v201, v201
  v_exp_f32 v202, v202
  v_exp_f32 v203, v203
  s_nop 0
  v_add_f32 v24, v200, v201
  v_add_f32 v25, v202, v203
  v_cvt_pk_bf16_f32 v200, v200, v201
  v_cvt_pk_bf16_f32 v201, v202, v203
  v_add_f32 v24, v24, v25
  v_add_f32 v19, v19, v24
  v_cndmask_b32 v44, 0, v200, s[48:49]
  v_cndmask_b32 v45, 0, v201, s[48:49]
  v_cndmask_b32 v46, 0, v200, s[50:51]
  v_cndmask_b32 v47, 0, v201, s[50:51]
  v_cndmask_b32 v48, 0, v200, s[52:53]
  v_cndmask_b32 v49, 0, v201, s[52:53]
  v_cndmask_b32 v50, 0, v200, s[54:55]
  v_cndmask_b32 v51, 0, v201, s[54:55]
  v_cndmask_b32 v52, 0, v200, s[56:57]
  v_cndmask_b32 v53, 0, v201, s[56:57]
  v_cndmask_b32 v54, 0, v200, s[58:59]
  v_cndmask_b32 v55, 0, v201, s[58:59]
  v_cndmask_b32 v56, 0, v200, s[60:61]
  v_cndmask_b32 v57, 0, v201, s[60:61]
  v_cndmask_b32 v58, 0, v200, s[62:63]
  v_cndmask_b32 v59, 0, v201, s[62:63]
  s_waitcnt lgkmcnt(0)
  s_waitcnt vmcnt(0)
  s_add_u32 m0, s42, 24576
  s_nop 0
  buffer_load_dwordx4 v2, s[28:31], s40 offen offset:0 nt lds
  buffer_load_dwordx4 v3, s[28:31], s40 offen offset:1024 nt lds
  buffer_load_dwordx4 v4, s[28:31], s40 offen offset:2048 nt lds
  buffer_load_dwordx4 v5, s[28:31], s40 offen offset:3072 nt lds
  s_add_u32 m0, s42, 28672
  s_nop 0
  buffer_load_dwordx4 v2, s[28:31], s41 offen offset:0 nt lds
  buffer_load_dwordx4 v3, s[28:31], s41 offen offset:1024 nt lds
  buffer_load_dwordx4 v4, s[28:31], s41 offen offset:2048 nt lds
  buffer_load_dwordx4 v5, s[28:31], s41 offen offset:3072 nt lds
  v_mfma_f32_16x16x16_bf16 v[36:39], v[92:93], v[44:45], v[36:39]
  v_mfma_f32_16x16x16_bf16 v[40:43], v[108:109], v[44:45], v[40:43]
  v_mfma_f32_16x16x16_bf16 v[36:39], v[94:95], v[46:47], v[36:39]
  v_mfma_f32_16x16x16_bf16 v[40:43], v[110:111], v[46:47], v[40:43]
  v_mfma_f32_16x16x16_bf16 v[36:39], v[96:97], v[48:49], v[36:39]
  v_mfma_f32_16x16x16_bf16 v[40:43], v[112:113], v[48:49], v[40:43]
  v_mfma_f32_16x16x16_bf16 v[36:39], v[98:99], v[50:51], v[36:39]
  v_mfma_f32_16x16x16_bf16 v[40:43], v[114:115], v[50:51], v[40:43]
  v_mfma_f32_16x16x16_bf16 v[36:39], v[100:101], v[52:53], v[36:39]
  v_mfma_f32_16x16x16_bf16 v[40:43], v[116:117], v[52:53], v[40:43]
  v_mfma_f32_16x16x16_bf16 v[36:39], v[102:103], v[54:55], v[36:39]
  v_mfma_f32_16x16x16_bf16 v[40:43], v[118:119], v[54:55], v[40:43]
  v_mfma_f32_16x16x16_bf16 v[36:39], v[104:105], v[56:57], v[36:39]
  v_mfma_f32_16x16x16_bf16 v[40:43], v[120:121], v[56:57], v[40:43]
  v_mfma_f32_16x16x16_bf16 v[36:39], v[106:107], v[58:59], v[36:39]
  v_mfma_f32_16x16x16_bf16 v[40:43], v[122:123], v[58:59], v[40:43]
  s_add_u32 s40, s64, 786432
  s_add_u32 s41, s40, 4096
  ds_read_b64_tr_b16 v[92:93], v10 offset:0
  ds_read_b64_tr_b16 v[94:95], v11 offset:0
  ds_read_b64_tr_b16 v[96:97], v12 offset:0
  ds_read_b64_tr_b16 v[98:99], v13 offset:0
  ds_read_b64_tr_b16 v[100:101], v14 offset:0
  ds_read_b64_tr_b16 v[102:103], v15 offset:0
  ds_read_b64_tr_b16 v[104:105], v16 offset:0
  ds_read_b64_tr_b16 v[106:107], v17 offset:0
  ds_read_b64_tr_b16 v[108:109], v10 offset:256
  ds_read_b64_tr_b16 v[110:111], v11 offset:256
  ds_read_b64_tr_b16 v[112:113], v12 offset:256
  ds_read_b64_tr_b16 v[114:115], v13 offset:256
  ds_read_b64_tr_b16 v[116:117], v14 offset:256
  ds_read_b64_tr_b16 v[118:119], v15 offset:256
  ds_read_b64_tr_b16 v[120:121], v16 offset:256
  ds_read_b64_tr_b16 v[122:123], v17 offset:256
  v_fma_f32 v204, v204, s96, -v18
  v_fma_f32 v205, v205, s96, -v18
  v_fma_f32 v206, v206, s96, -v18
  v_fma_f32 v207, v207, s96, -v18
  v_exp_f32 v204, v204
  v_exp_f32 v205, v205
  v_exp_f32 v206, v206
  v_exp_f32 v207, v207
  s_nop 0
  v_add_f32 v24, v204, v205
  v_add_f32 v25, v206, v207
  v_cvt_pk_bf16_f32 v204, v204, v205
  v_cvt_pk_bf16_f32 v205, v206, v207
  v_add_f32 v24, v24, v25
  v_add_f32 v19, v19, v24
  v_cndmask_b32 v44, 0, v204, s[48:49]
  v_cndmask_b32 v45, 0, v205, s[48:49]
  v_cndmask_b32 v46, 0, v204, s[50:51]
  v_cndmask_b32 v47, 0, v205, s[50:51]
  v_cndmask_b32 v48, 0, v204, s[52:53]
  v_cndmask_b32 v49, 0, v205, s[52:53]
  v_cndmask_b32 v50, 0, v204, s[54:55]
  v_cndmask_b32 v51, 0, v205, s[54:55]
  v_cndmask_b32 v52, 0, v204, s[56:57]
  v_cndmask_b32 v53, 0, v205, s[56:57]
  v_cndmask_b32 v54, 0, v204, s[58:59]
  v_cndmask_b32 v55, 0, v205, s[58:59]
  v_cndmask_b32 v56, 0, v204, s[60:61]
  v_cndmask_b32 v57, 0, v205, s[60:61]
  v_cndmask_b32 v58, 0, v204, s[62:63]
  v_cndmask_b32 v59, 0, v205, s[62:63]
  s_waitcnt lgkmcnt(0)
  s_waitcnt vmcnt(0)
  s_add_u32 m0, s42, 0
  s_nop 0
  buffer_load_dwordx4 v2, s[24:27], s40 offen offset:0 nt lds
  buffer_load_dwordx4 v3, s[24:27], s40 offen offset:1024 nt lds
  buffer_load_dwordx4 v4, s[24:27], s40 offen offset:2048 nt lds
  buffer_load_dwordx4 v5, s[24:27], s40 offen offset:3072 nt lds
  s_add_u32 m0, s42, 4096
  s_nop 0
  buffer_load_dwordx4 v2, s[24:27], s41 offen offset:0 nt lds
  buffer_load_dwordx4 v3, s[24:27], s41 offen offset:1024 nt lds
  buffer_load_dwordx4 v4, s[24:27], s41 offen offset:2048 nt lds
  buffer_load_dwordx4 v5, s[24:27], s41 offen offset:3072 nt lds
  v_mfma_f32_16x16x16_bf16 v[36:39], v[92:93], v[44:45], v[36:39]
  v_mfma_f32_16x16x16_bf16 v[40:43], v[108:109], v[44:45], v[40:43]
  v_mfma_f32_16x16x16_bf16 v[36:39], v[94:95], v[46:47], v[36:39]
  v_mfma_f32_16x16x16_bf16 v[40:43], v[110:111], v[46:47], v[40:43]
  v_mfma_f32_16x16x16_bf16 v[36:39], v[96:97], v[48:49], v[36:39]
  v_mfma_f32_16x16x16_bf16 v[40:43], v[112:113], v[48:49], v[40:43]
  v_mfma_f32_16x16x16_bf16 v[36:39], v[98:99], v[50:51], v[36:39]
  v_mfma_f32_16x16x16_bf16 v[40:43], v[114:115], v[50:51], v[40:43]
  v_mfma_f32_16x16x16_bf16 v[36:39], v[100:101], v[52:53], v[36:39]
  v_mfma_f32_16x16x16_bf16 v[40:43], v[116:117], v[52:53], v[40:43]
  v_mfma_f32_16x16x16_bf16 v[36:39], v[102:103], v[54:55], v[36:39]
  v_mfma_f32_16x16x16_bf16 v[40:43], v[118:119], v[54:55], v[40:43]
  v_mfma_f32_16x16x16_bf16 v[36:39], v[104:105], v[56:57], v[36:39]
  v_mfma_f32_16x16x16_bf16 v[40:43], v[120:121], v[56:57], v[40:43]
  v_mfma_f32_16x16x16_bf16 v[36:39], v[106:107], v[58:59], v[36:39]
  v_mfma_f32_16x16x16_bf16 v[40:43], v[122:123], v[58:59], v[40:43]
  s_add_u32 s40, s64, 786432
  s_add_u32 s41, s40, 4096
  ds_read_b64_tr_b16 v[92:93], v10 offset:8192
  ds_read_b64_tr_b16 v[94:95], v11 offset:8192
  ds_read_b64_tr_b16 v[96:97], v12 offset:8192
  ds_read_b64_tr_b16 v[98:99], v13 offset:8192
  ds_read_b64_tr_b16 v[100:101], v14 offset:8192
  ds_read_b64_tr_b16 v[102:103], v15 offset:8192
  ds_read_b64_tr_b16 v[104:105], v16 offset:8192
  ds_read_b64_tr_b16 v[106:107], v17 offset:8192
  ds_read_b64_tr_b16 v[108:109], v10 offset:8448
  ds_read_b64_tr_b16 v[110:111], v11 offset:8448
  ds_read_b64_tr_b16 v[112:113], v12 offset:8448
  ds_read_b64_tr_b16 v[114:115], v13 offset:8448
  ds_read_b64_tr_b16 v[116:117], v14 offset:8448
  ds_read_b64_tr_b16 v[118:119], v15 offset:8448
  ds_read_b64_tr_b16 v[120:121], v16 offset:8448
  ds_read_b64_tr_b16 v[122:123], v17 offset:8448
  v_fma_f32 v208, v208, s96, -v18
  v_fma_f32 v209, v209, s96, -v18
  v_fma_f32 v210, v210, s96, -v18
  v_fma_f32 v211, v211, s96, -v18
  v_exp_f32 v208, v208
  v_exp_f32 v209, v209
  v_exp_f32 v210, v210
  v_exp_f32 v211, v211
  s_nop 0
  v_add_f32 v24, v208, v209
  v_add_f32 v25, v210, v211
  v_cvt_pk_bf16_f32 v208, v208, v209
  v_cvt_pk_bf16_f32 v209, v210, v211
  v_add_f32 v24, v24, v25
  v_add_f32 v19, v19, v24
  v_cndmask_b32 v44, 0, v208, s[48:49]
  v_cndmask_b32 v45, 0, v209, s[48:49]
  v_cndmask_b32 v46, 0, v208, s[50:51]
  v_cndmask_b32 v47, 0, v209, s[50:51]
  v_cndmask_b32 v48, 0, v208, s[52:53]
  v_cndmask_b32 v49, 0, v209, s[52:53]
  v_cndmask_b32 v50, 0, v208, s[54:55]
  v_cndmask_b32 v51, 0, v209, s[54:55]
  v_cndmask_b32 v52, 0, v208, s[56:57]
  v_cndmask_b32 v53, 0, v209, s[56:57]
  v_cndmask_b32 v54, 0, v208, s[58:59]
  v_cndmask_b32 v55, 0, v209, s[58:59]
  v_cndmask_b32 v56, 0, v208, s[60:61]
  v_cndmask_b32 v57, 0, v209, s[60:61]
  v_cndmask_b32 v58, 0, v208, s[62:63]
  v_cndmask_b32 v59, 0, v209, s[62:63]
  s_waitcnt lgkmcnt(0)
  s_waitcnt vmcnt(0)
  s_add_u32 m0, s42, 8192
  s_nop 0
  buffer_load_dwordx4 v2, s[28:31], s40 offen offset:0 nt lds
  buffer_load_dwordx4 v3, s[28:31], s40 offen offset:1024 nt lds
  buffer_load_dwordx4 v4, s[28:31], s40 offen offset:2048 nt lds
  buffer_load_dwordx4 v5, s[28:31], s40 offen offset:3072 nt lds
  s_add_u32 m0, s42, 12288
  s_nop 0
  buffer_load_dwordx4 v2, s[28:31], s41 offen offset:0 nt lds
  buffer_load_dwordx4 v3, s[28:31], s41 offen offset:1024 nt lds
  buffer_load_dwordx4 v4, s[28:31], s41 offen offset:2048 nt lds
  buffer_load_dwordx4 v5, s[28:31], s41 offen offset:3072 nt lds
  v_mfma_f32_16x16x16_bf16 v[36:39], v[92:93], v[44:45], v[36:39]
  v_mfma_f32_16x16x16_bf16 v[40:43], v[108:109], v[44:45], v[40:43]
  v_mfma_f32_16x16x16_bf16 v[36:39], v[94:95], v[46:47], v[36:39]
  v_mfma_f32_16x16x16_bf16 v[40:43], v[110:111], v[46:47], v[40:43]
  v_mfma_f32_16x16x16_bf16 v[36:39], v[96:97], v[48:49], v[36:39]
  v_mfma_f32_16x16x16_bf16 v[40:43], v[112:113], v[48:49], v[40:43]
  v_mfma_f32_16x16x16_bf16 v[36:39], v[98:99], v[50:51], v[36:39]
  v_mfma_f32_16x16x16_bf16 v[40:43], v[114:115], v[50:51], v[40:43]
  v_mfma_f32_16x16x16_bf16 v[36:39], v[100:101], v[52:53], v[36:39]
  v_mfma_f32_16x16x16_bf16 v[40:43], v[116:117], v[52:53], v[40:43]
  v_mfma_f32_16x16x16_bf16 v[36:39], v[102:103], v[54:55], v[36:39]
  v_mfma_f32_16x16x16_bf16 v[40:43], v[118:119], v[54:55], v[40:43]
  v_mfma_f32_16x16x16_bf16 v[36:39], v[104:105], v[56:57], v[36:39]
  v_mfma_f32_16x16x16_bf16 v[40:43], v[120:121], v[56:57], v[40:43]
  v_mfma_f32_16x16x16_bf16 v[36:39], v[106:107], v[58:59], v[36:39]
  v_mfma_f32_16x16x16_bf16 v[40:43], v[122:123], v[58:59], v[40:43]
  s_add_u32 s40, s64, 819200
  s_add_u32 s41, s40, 4096
  ds_read_b64_tr_b16 v[92:93], v10 offset:16384
  ds_read_b64_tr_b16 v[94:95], v11 offset:16384
  ds_read_b64_tr_b16 v[96:97], v12 offset:16384
  ds_read_b64_tr_b16 v[98:99], v13 offset:16384
  ds_read_b64_tr_b16 v[100:101], v14 offset:16384
  ds_read_b64_tr_b16 v[102:103], v15 offset:16384
  ds_read_b64_tr_b16 v[104:105], v16 offset:16384
  ds_read_b64_tr_b16 v[106:107], v17 offset:16384
  ds_read_b64_tr_b16 v[108:109], v10 offset:16640
  ds_read_b64_tr_b16 v[110:111], v11 offset:16640
  ds_read_b64_tr_b16 v[112:113], v12 offset:16640
  ds_read_b64_tr_b16 v[114:115], v13 offset:16640
  ds_read_b64_tr_b16 v[116:117], v14 offset:16640
  ds_read_b64_tr_b16 v[118:119], v15 offset:16640
  ds_read_b64_tr_b16 v[120:121], v16 offset:16640
  ds_read_b64_tr_b16 v[122:123], v17 offset:16640
  v_fma_f32 v212, v212, s96, -v18
  v_fma_f32 v213, v213, s96, -v18
  v_fma_f32 v214, v214, s96, -v18
  v_fma_f32 v215, v215, s96, -v18
  v_exp_f32 v212, v212
  v_exp_f32 v213, v213
  v_exp_f32 v214, v214
  v_exp_f32 v215, v215
  s_nop 0
  v_add_f32 v24, v212, v213
  v_add_f32 v25, v214, v215
  v_cvt_pk_bf16_f32 v212, v212, v213
  v_cvt_pk_bf16_f32 v213, v214, v215
  v_add_f32 v24, v24, v25
  v_add_f32 v19, v19, v24
  v_cndmask_b32 v44, 0, v212, s[48:49]
  v_cndmask_b32 v45, 0, v213, s[48:49]
  v_cndmask_b32 v46, 0, v212, s[50:51]
  v_cndmask_b32 v47, 0, v213, s[50:51]
  v_cndmask_b32 v48, 0, v212, s[52:53]
  v_cndmask_b32 v49, 0, v213, s[52:53]
  v_cndmask_b32 v50, 0, v212, s[54:55]
  v_cndmask_b32 v51, 0, v213, s[54:55]
  v_cndmask_b32 v52, 0, v212, s[56:57]
  v_cndmask_b32 v53, 0, v213, s[56:57]
  v_cndmask_b32 v54, 0, v212, s[58:59]
  v_cndmask_b32 v55, 0, v213, s[58:59]
  v_cndmask_b32 v56, 0, v212, s[60:61]
  v_cndmask_b32 v57, 0, v213, s[60:61]
  v_cndmask_b32 v58, 0, v212, s[62:63]
  v_cndmask_b32 v59, 0, v213, s[62:63]
  s_waitcnt lgkmcnt(0)
  s_waitcnt vmcnt(0)
  s_add_u32 m0, s42, 16384
  s_nop 0
  buffer_load_dwordx4 v2, s[24:27], s40 offen offset:0 nt lds
  buffer_load_dwordx4 v3, s[24:27], s40 offen offset:1024 nt lds
  buffer_load_dwordx4 v4, s[24:27], s40 offen offset:2048 nt lds
  buffer_load_dwordx4 v5, s[24:27], s40 offen offset:3072 nt lds
  s_add_u32 m0, s42, 20480
  s_nop 0
  buffer_load_dwordx4 v2, s[24:27], s41 offen offset:0 nt lds
  buffer_load_dwordx4 v3, s[24:27], s41 offen offset:1024 nt lds
  buffer_load_dwordx4 v4, s[24:27], s41 offen offset:2048 nt lds
  buffer_load_dwordx4 v5, s[24:27], s41 offen offset:3072 nt lds
  v_mfma_f32_16x16x16_bf16 v[36:39], v[92:93], v[44:45], v[36:39]
  v_mfma_f32_16x16x16_bf16 v[40:43], v[108:109], v[44:45], v[40:43]
  v_mfma_f32_16x16x16_bf16 v[36:39], v[94:95], v[46:47], v[36:39]
  v_mfma_f32_16x16x16_bf16 v[40:43], v[110:111], v[46:47], v[40:43]
  v_mfma_f32_16x16x16_bf16 v[36:39], v[96:97], v[48:49], v[36:39]
  v_mfma_f32_16x16x16_bf16 v[40:43], v[112:113], v[48:49], v[40:43]
  v_mfma_f32_16x16x16_bf16 v[36:39], v[98:99], v[50:51], v[36:39]
  v_mfma_f32_16x16x16_bf16 v[40:43], v[114:115], v[50:51], v[40:43]
  v_mfma_f32_16x16x16_bf16 v[36:39], v[100:101], v[52:53], v[36:39]
  v_mfma_f32_16x16x16_bf16 v[40:43], v[116:117], v[52:53], v[40:43]
  v_mfma_f32_16x16x16_bf16 v[36:39], v[102:103], v[54:55], v[36:39]
  v_mfma_f32_16x16x16_bf16 v[40:43], v[118:119], v[54:55], v[40:43]
  v_mfma_f32_16x16x16_bf16 v[36:39], v[104:105], v[56:57], v[36:39]
  v_mfma_f32_16x16x16_bf16 v[40:43], v[120:121], v[56:57], v[40:43]
  v_mfma_f32_16x16x16_bf16 v[36:39], v[106:107], v[58:59], v[36:39]
  v_mfma_f32_16x16x16_bf16 v[40:43], v[122:123], v[58:59], v[40:43]
  s_add_u32 s40, s64, 819200
  s_add_u32 s41, s40, 4096
  ds_read_b64_tr_b16 v[92:93], v10 offset:24576
  ds_read_b64_tr_b16 v[94:95], v11 offset:24576
  ds_read_b64_tr_b16 v[96:97], v12 offset:24576
  ds_read_b64_tr_b16 v[98:99], v13 offset:24576
  ds_read_b64_tr_b16 v[100:101], v14 offset:24576
  ds_read_b64_tr_b16 v[102:103], v15 offset:24576
  ds_read_b64_tr_b16 v[104:105], v16 offset:24576
  ds_read_b64_tr_b16 v[106:107], v17 offset:24576
  ds_read_b64_tr_b16 v[108:109], v10 offset:24832
  ds_read_b64_tr_b16 v[110:111], v11 offset:24832
  ds_read_b64_tr_b16 v[112:113], v12 offset:24832
  ds_read_b64_tr_b16 v[114:115], v13 offset:24832
  ds_read_b64_tr_b16 v[116:117], v14 offset:24832
  ds_read_b64_tr_b16 v[118:119], v15 offset:24832
  ds_read_b64_tr_b16 v[120:121], v16 offset:24832
  ds_read_b64_tr_b16 v[122:123], v17 offset:24832
  v_fma_f32 v216, v216, s96, -v18
  v_fma_f32 v217, v217, s96, -v18
  v_fma_f32 v218, v218, s96, -v18
  v_fma_f32 v219, v219, s96, -v18
  v_exp_f32 v216, v216
  v_exp_f32 v217, v217
  v_exp_f32 v218, v218
  v_exp_f32 v219, v219
  s_nop 0
  v_add_f32 v24, v216, v217
  v_add_f32 v25, v218, v219
  v_cvt_pk_bf16_f32 v216, v216, v217
  v_cvt_pk_bf16_f32 v217, v218, v219
  v_add_f32 v24, v24, v25
  v_add_f32 v19, v19, v24
  v_cndmask_b32 v44, 0, v216, s[48:49]
  v_cndmask_b32 v45, 0, v217, s[48:49]
  v_cndmask_b32 v46, 0, v216, s[50:51]
  v_cndmask_b32 v47, 0, v217, s[50:51]
  v_cndmask_b32 v48, 0, v216, s[52:53]
  v_cndmask_b32 v49, 0, v217, s[52:53]
  v_cndmask_b32 v50, 0, v216, s[54:55]
  v_cndmask_b32 v51, 0, v217, s[54:55]
  v_cndmask_b32 v52, 0, v216, s[56:57]
  v_cndmask_b32 v53, 0, v217, s[56:57]
  v_cndmask_b32 v54, 0, v216, s[58:59]
  v_cndmask_b32 v55, 0, v217, s[58:59]
  v_cndmask_b32 v56, 0, v216, s[60:61]
  v_cndmask_b32 v57, 0, v217, s[60:61]
  v_cndmask_b32 v58, 0, v216, s[62:63]
  v_cndmask_b32 v59, 0, v217, s[62:63]
  s_waitcnt lgkmcnt(0)
  s_waitcnt vmcnt(0)
  s_add_u32 m0, s42, 24576
  s_nop 0
  buffer_load_dwordx4 v2, s[28:31], s40 offen offset:0 nt lds
  buffer_load_dwordx4 v3, s[28:31], s40 offen offset:1024 nt lds
  buffer_load_dwordx4 v4, s[28:31], s40 offen offset:2048 nt lds
  buffer_load_dwordx4 v5, s[28:31], s40 offen offset:3072 nt lds
  s_add_u32 m0, s42, 28672
  s_nop 0
  buffer_load_dwordx4 v2, s[28:31], s41 offen offset:0 nt lds
  buffer_load_dwordx4 v3, s[28:31], s41 offen offset:1024 nt lds
  buffer_load_dwordx4 v4, s[28:31], s41 offen offset:2048 nt lds
  buffer_load_dwordx4 v5, s[28:31], s41 offen offset:3072 nt lds
  v_mfma_f32_16x16x16_bf16 v[36:39], v[92:93], v[44:45], v[36:39]
  v_mfma_f32_16x16x16_bf16 v[40:43], v[108:109], v[44:45], v[40:43]
  v_mfma_f32_16x16x16_bf16 v[36:39], v[94:95], v[46:47], v[36:39]
  v_mfma_f32_16x16x16_bf16 v[40:43], v[110:111], v[46:47], v[40:43]
  v_mfma_f32_16x16x16_bf16 v[36:39], v[96:97], v[48:49], v[36:39]
  v_mfma_f32_16x16x16_bf16 v[40:43], v[112:113], v[48:49], v[40:43]
  v_mfma_f32_16x16x16_bf16 v[36:39], v[98:99], v[50:51], v[36:39]
  v_mfma_f32_16x16x16_bf16 v[40:43], v[114:115], v[50:51], v[40:43]
  v_mfma_f32_16x16x16_bf16 v[36:39], v[100:101], v[52:53], v[36:39]
  v_mfma_f32_16x16x16_bf16 v[40:43], v[116:117], v[52:53], v[40:43]
  v_mfma_f32_16x16x16_bf16 v[36:39], v[102:103], v[54:55], v[36:39]
  v_mfma_f32_16x16x16_bf16 v[40:43], v[118:119], v[54:55], v[40:43]
  v_mfma_f32_16x16x16_bf16 v[36:39], v[104:105], v[56:57], v[36:39]
  v_mfma_f32_16x16x16_bf16 v[40:43], v[120:121], v[56:57], v[40:43]
  v_mfma_f32_16x16x16_bf16 v[36:39], v[106:107], v[58:59], v[36:39]
  v_mfma_f32_16x16x16_bf16 v[40:43], v[122:123], v[58:59], v[40:43]
  s_mov_b32 s65, 0
  s_lshl_b32 s66, s3, 5
  s_add_u32 s66, s66, 160768
  s_mov_b32 s100, 26
L_pool0_concat_heads__gqa_block_cached__gqa_block_cached__decode_kernel:
  s_and_b32 s43, s65, 7
  s_lshl_b32 s43, s43, 2
  s_add_u32 s43, s43, s66
  v_mov_b32 v26, s43
  s_add_u32 s65, s65, 1
  s_mov_b32 s67, 0
Ltk_concat_heads__gqa_block_cached__gqa_block_cached__decode_kernel_2:
  ds_read_b32 v27, v26
  s_waitcnt lgkmcnt(0)
  v_readfirstlane_b32 s43, v27
  s_add_u32 s67, s67, 1
  s_cmp_gt_u32 s67, 3200000
  s_cbranch_scc1 L_tail0_concat_heads__gqa_block_cached__gqa_block_cached__decode_kernel
  s_lshr_b32 s44, s43, 12
  s_cmp_eq_u32 s44, s65
  s_cbranch_scc0 Ltk_concat_heads__gqa_block_cached__gqa_block_cached__decode_kernel_2
  s_lshl_b32 s44, s3, 2
  s_add_u32 s44, s44, 160896
  v_mov_b32 v26, s44
  v_mov_b32 v27, s65
  ds_write_b32 v26, v27
  s_and_b32 s43, s43, 0xfff
  s_cmp_eq_u32 s43, 4095
  s_cbranch_scc1 L_tail0_concat_heads__gqa_block_cached__gqa_block_cached__decode_kernel
  s_and_b32 s44, s43, 3
  s_lshr_b32 s43, s43, 2
  s_lshl_b32 s44, s44, 7
  s_add_u32 s43, s43, s44
  s_add_u32 s43, s43, 104
  s_lshl_b32 s40, s43, 13
  s_add_u32 s41, s40, 4096
  s_waitcnt vmcnt(24)
  ds_read_b128 v[92:95], v6 offset:0
  ds_read_b128 v[96:99], v7 offset:0
  ds_read_b128 v[100:103], v8 offset:0
  ds_read_b128 v[104:107], v9 offset:0
  ds_read_b128 v[108:111], v6 offset:256
  ds_read_b128 v[112:115], v7 offset:256
  ds_read_b128 v[116:119], v8 offset:256
  ds_read_b128 v[120:123], v9 offset:256
  s_waitcnt lgkmcnt(0)
  s_waitcnt vmcnt(0)
  s_add_u32 m0, s42, 0
  s_nop 0
  buffer_load_dwordx4 v2, s[24:27], s40 offen offset:0 nt lds
  buffer_load_dwordx4 v3, s[24:27], s40 offen offset:1024 nt lds
  buffer_load_dwordx4 v4, s[24:27], s40 offen offset:2048 nt lds
  buffer_load_dwordx4 v5, s[24:27], s40 offen offset:3072 nt lds
  s_add_u32 m0, s42, 4096
  s_nop 0
  buffer_load_dwordx4 v2, s[24:27], s41 offen offset:0 nt lds
  buffer_load_dwordx4 v3, s[24:27], s41 offen offset:1024 nt lds
  buffer_load_dwordx4 v4, s[24:27], s41 offen offset:2048 nt lds
  buffer_load_dwordx4 v5, s[24:27], s41 offen offset:3072 nt lds
  v_mfma_f32_16x16x32_bf16 v[124:127], v[92:95], v[60:63], 0
  v_mfma_f32_16x16x32_bf16 v[124:127], v[96:99], v[64:67], v[124:127]
  v_mfma_f32_16x16x32_bf16 v[124:127], v[100:103], v[68:71], v[124:127]
  v_mfma_f32_16x16x32_bf16 v[124:127], v[104:107], v[72:75], v[124:127]
  v_mfma_f32_16x16x32_bf16 v[124:127], v[108:111], v[76:79], v[124:127]
  v_mfma_f32_16x16x32_bf16 v[124:127], v[112:115], v[80:83], v[124:127]
  v_mfma_f32_16x16x32_bf16 v[124:127], v[116:119], v[84:87], v[124:127]
  v_mfma_f32_16x16x32_bf16 v[124:127], v[120:123], v[88:91], v[124:127]
  s_nop 7
  v_cvt_pk_bf16_f32 v26, v124, v125
  v_lshlrev_b32 v124, 16, v26
  v_and_b32 v125, 0xffff0000, v26
  v_cvt_pk_bf16_f32 v27, v126, v127
  v_lshlrev_b32 v126, 16, v27
  v_and_b32 v127, 0xffff0000, v27
  v_max3_f32 v252, v124, v125, v126
  v_max_f32 v252, v252, v127
  v_mov_b32 v21, v252
  v_mov_b32 v22, v252
  s_nop 1
  v_permlane16_swap_b32 v21, v22
  s_nop 1
  v_max_f32 v252, v21, v22
  v_mov_b32 v21, v252
  v_mov_b32 v22, v252
  s_nop 1
  v_permlane32_swap_b32 v21, v22
  s_nop 1
  v_max_f32 v252, v21, v22
  v_mul_f32 v20, s96, v252
  v_max_f32 v20, v20, v18
  v_sub_f32 v21, v18, v20
  v_exp_f32 v21, v21
  v_mov_b32 v18, v20
  v_mul_f32 v19, v19, v21
  v_mul_f32 v36, v36, v21
  v_mul_f32 v37, v37, v21
  v_mul_f32 v38, v38, v21
  v_mul_f32 v39, v39, v21
  v_mul_f32 v40, v40, v21
  v_mul_f32 v41, v41, v21
  v_mul_f32 v42, v42, v21
  v_mul_f32 v43, v43, v21
  s_waitcnt vmcnt(24)
  ds_read_b64_tr_b16 v[92:93], v10 offset:8192
  ds_read_b64_tr_b16 v[94:95], v11 offset:8192
  ds_read_b64_tr_b16 v[96:97], v12 offset:8192
  ds_read_b64_tr_b16 v[98:99], v13 offset:8192
  ds_read_b64_tr_b16 v[100:101], v14 offset:8192
  ds_read_b64_tr_b16 v[102:103], v15 offset:8192
  ds_read_b64_tr_b16 v[104:105], v16 offset:8192
  ds_read_b64_tr_b16 v[106:107], v17 offset:8192
  ds_read_b64_tr_b16 v[108:109], v10 offset:8448
  ds_read_b64_tr_b16 v[110:111], v11 offset:8448
  ds_read_b64_tr_b16 v[112:113], v12 offset:8448
  ds_read_b64_tr_b16 v[114:115], v13 offset:8448
  ds_read_b64_tr_b16 v[116:117], v14 offset:8448
  ds_read_b64_tr_b16 v[118:119], v15 offset:8448
  ds_read_b64_tr_b16 v[120:121], v16 offset:8448
  ds_read_b64_tr_b16 v[122:123], v17 offset:8448
  v_fma_f32 v124, v124, s96, -v18
  v_fma_f32 v125, v125, s96, -v18
  v_fma_f32 v126, v126, s96, -v18
  v_fma_f32 v127, v127, s96, -v18
  v_exp_f32 v124, v124
  v_exp_f32 v125, v125
  v_exp_f32 v126, v126
  v_exp_f32 v127, v127
  s_nop 0
  v_add_f32 v24, v124, v125
  v_add_f32 v25, v126, v127
  v_cvt_pk_bf16_f32 v124, v124, v125
  v_cvt_pk_bf16_f32 v125, v126, v127
  v_add_f32 v24, v24, v25
  v_add_f32 v19, v19, v24
  v_cndmask_b32 v44, 0, v124, s[48:49]
  v_cndmask_b32 v45, 0, v125, s[48:49]
  v_cndmask_b32 v46, 0, v124, s[50:51]
  v_cndmask_b32 v47, 0, v125, s[50:51]
  v_cndmask_b32 v48, 0, v124, s[52:53]
  v_cndmask_b32 v49, 0, v125, s[52:53]
  v_cndmask_b32 v50, 0, v124, s[54:55]
  v_cndmask_b32 v51, 0, v125, s[54:55]
  v_cndmask_b32 v52, 0, v124, s[56:57]
  v_cndmask_b32 v53, 0, v125, s[56:57]
  v_cndmask_b32 v54, 0, v124, s[58:59]
  v_cndmask_b32 v55, 0, v125, s[58:59]
  v_cndmask_b32 v56, 0, v124, s[60:61]
  v_cndmask_b32 v57, 0, v125, s[60:61]
  v_cndmask_b32 v58, 0, v124, s[62:63]
  v_cndmask_b32 v59, 0, v125, s[62:63]
  s_waitcnt lgkmcnt(0)
  s_waitcnt vmcnt(0)
  s_add_u32 m0, s42, 8192
  s_nop 0
  buffer_load_dwordx4 v2, s[28:31], s40 offen offset:0 nt lds
  buffer_load_dwordx4 v3, s[28:31], s40 offen offset:1024 nt lds
  buffer_load_dwordx4 v4, s[28:31], s40 offen offset:2048 nt lds
  buffer_load_dwordx4 v5, s[28:31], s40 offen offset:3072 nt lds
  s_add_u32 m0, s42, 12288
  s_nop 0
  buffer_load_dwordx4 v2, s[28:31], s41 offen offset:0 nt lds
  buffer_load_dwordx4 v3, s[28:31], s41 offen offset:1024 nt lds
  buffer_load_dwordx4 v4, s[28:31], s41 offen offset:2048 nt lds
  buffer_load_dwordx4 v5, s[28:31], s41 offen offset:3072 nt lds
  v_mfma_f32_16x16x16_bf16 v[36:39], v[92:93], v[44:45], v[36:39]
  v_mfma_f32_16x16x16_bf16 v[40:43], v[108:109], v[44:45], v[40:43]
  v_mfma_f32_16x16x16_bf16 v[36:39], v[94:95], v[46:47], v[36:39]
  v_mfma_f32_16x16x16_bf16 v[40:43], v[110:111], v[46:47], v[40:43]
  v_mfma_f32_16x16x16_bf16 v[36:39], v[96:97], v[48:49], v[36:39]
  v_mfma_f32_16x16x16_bf16 v[40:43], v[112:113], v[48:49], v[40:43]
  v_mfma_f32_16x16x16_bf16 v[36:39], v[98:99], v[50:51], v[36:39]
  v_mfma_f32_16x16x16_bf16 v[40:43], v[114:115], v[50:51], v[40:43]
  v_mfma_f32_16x16x16_bf16 v[36:39], v[100:101], v[52:53], v[36:39]
  v_mfma_f32_16x16x16_bf16 v[40:43], v[116:117], v[52:53], v[40:43]
  v_mfma_f32_16x16x16_bf16 v[36:39], v[102:103], v[54:55], v[36:39]
  v_mfma_f32_16x16x16_bf16 v[40:43], v[118:119], v[54:55], v[40:43]
  v_mfma_f32_16x16x16_bf16 v[36:39], v[104:105], v[56:57], v[36:39]
  v_mfma_f32_16x16x16_bf16 v[40:43], v[120:121], v[56:57], v[40:43]
  v_mfma_f32_16x16x16_bf16 v[36:39], v[106:107], v[58:59], v[36:39]
  v_mfma_f32_16x16x16_bf16 v[40:43], v[122:123], v[58:59], v[40:43]
  s_and_b32 s43, s65, 7
  s_lshl_b32 s43, s43, 2
  s_add_u32 s43, s43, s66
  v_mov_b32 v26, s43
  s_add_u32 s65, s65, 1
  s_mov_b32 s67, 0
Ltk_concat_heads__gqa_block_cached__gqa_block_cached__decode_kernel_3:
  ds_read_b32 v27, v26
  s_waitcnt lgkmcnt(0)
  v_readfirstlane_b32 s43, v27
  s_add_u32 s67, s67, 1
  s_cmp_gt_u32 s67, 3200000
  s_cbranch_scc1 L_tail1_concat_heads__gqa_block_cached__gqa_block_cached__decode_kernel
  s_lshr_b32 s44, s43, 12
  s_cmp_eq_u32 s44, s65
  s_cbranch_scc0 Ltk_concat_heads__gqa_block_cached__gqa_block_cached__decode_kernel_3
  s_lshl_b32 s44, s3, 2
  s_add_u32 s44, s44, 160896
  v_mov_b32 v26, s44
  v_mov_b32 v27, s65
  ds_write_b32 v26, v27
  s_and_b32 s43, s43, 0xfff
  s_cmp_eq_u32 s43, 4095
  s_cbranch_scc1 L_tail1_concat_heads__gqa_block_cached__gqa_block_cached__decode_kernel
  s_and_b32 s44, s43, 3
  s_lshr_b32 s43, s43, 2
  s_lshl_b32 s44, s44, 7
  s_add_u32 s43, s43, s44
  s_add_u32 s43, s43, 104
  s_lshl_b32 s40, s43, 13
  s_add_u32 s41, s40, 4096
  s_waitcnt vmcnt(24)
  ds_read_b128 v[92:95], v6 offset:16384
  ds_read_b128 v[96:99], v7 offset:16384
  ds_read_b128 v[100:103], v8 offset:16384
  ds_read_b128 v[104:107], v9 offset:16384
  ds_read_b128 v[108:111], v6 offset:16640
  ds_read_b128 v[112:115], v7 offset:16640
  ds_read_b128 v[116:119], v8 offset:16640
  ds_read_b128 v[120:123], v9 offset:16640
  s_waitcnt lgkmcnt(0)
  s_waitcnt vmcnt(0)
  s_add_u32 m0, s42, 16384
  s_nop 0
  buffer_load_dwordx4 v2, s[24:27], s40 offen offset:0 nt lds
  buffer_load_dwordx4 v3, s[24:27], s40 offen offset:1024 nt lds
  buffer_load_dwordx4 v4, s[24:27], s40 offen offset:2048 nt lds
  buffer_load_dwordx4 v5, s[24:27], s40 offen offset:3072 nt lds
  s_add_u32 m0, s42, 20480
  s_nop 0
  buffer_load_dwordx4 v2, s[24:27], s41 offen offset:0 nt lds
  buffer_load_dwordx4 v3, s[24:27], s41 offen offset:1024 nt lds
  buffer_load_dwordx4 v4, s[24:27], s41 offen offset:2048 nt lds
  buffer_load_dwordx4 v5, s[24:27], s41 offen offset:3072 nt lds
  v_mfma_f32_16x16x32_bf16 v[124:127], v[92:95], v[60:63], 0
  v_mfma_f32_16x16x32_bf16 v[124:127], v[96:99], v[64:67], v[124:127]
  v_mfma_f32_16x16x32_bf16 v[124:127], v[100:103], v[68:71], v[124:127]
  v_mfma_f32_16x16x32_bf16 v[124:127], v[104:107], v[72:75], v[124:127]
  v_mfma_f32_16x16x32_bf16 v[124:127], v[108:111], v[76:79], v[124:127]
  v_mfma_f32_16x16x32_bf16 v[124:127], v[112:115], v[80:83], v[124:127]
  v_mfma_f32_16x16x32_bf16 v[124:127], v[116:119], v[84:87], v[124:127]
  v_mfma_f32_16x16x32_bf16 v[124:127], v[120:123], v[88:91], v[124:127]
  s_nop 7
  v_cvt_pk_bf16_f32 v26, v124, v125
  v_lshlrev_b32 v124, 16, v26
  v_and_b32 v125, 0xffff0000, v26
  v_cvt_pk_bf16_f32 v27, v126, v127
  v_lshlrev_b32 v126, 16, v27
  v_and_b32 v127, 0xffff0000, v27
  v_max3_f32 v252, v124, v125, v126
  v_max_f32 v252, v252, v127
  v_mov_b32 v21, v252
  v_mov_b32 v22, v252
  s_nop 1
  v_permlane16_swap_b32 v21, v22
  s_nop 1
  v_max_f32 v252, v21, v22
  v_mov_b32 v21, v252
  v_mov_b32 v22, v252
  s_nop 1
  v_permlane32_swap_b32 v21, v22
  s_nop 1
  v_max_f32 v252, v21, v22
  v_mul_f32 v20, s96, v252
  v_max_f32 v20, v20, v18
  v_sub_f32 v21, v18, v20
  v_exp_f32 v21, v21
  v_mov_b32 v18, v20
  v_mul_f32 v19, v19, v21
  v_mul_f32 v36, v36, v21
  v_mul_f32 v37, v37, v21
  v_mul_f32 v38, v38, v21
  v_mul_f32 v39, v39, v21
  v_mul_f32 v40, v40, v21
  v_mul_f32 v41, v41, v21
  v_mul_f32 v42, v42, v21
  v_mul_f32 v43, v43, v21
  s_waitcnt vmcnt(24)
  ds_read_b64_tr_b16 v[92:93], v10 offset:24576
  ds_read_b64_tr_b16 v[94:95], v11 offset:24576
  ds_read_b64_tr_b16 v[96:97], v12 offset:24576
  ds_read_b64_tr_b16 v[98:99], v13 offset:24576
  ds_read_b64_tr_b16 v[100:101], v14 offset:24576
  ds_read_b64_tr_b16 v[102:103], v15 offset:24576
  ds_read_b64_tr_b16 v[104:105], v16 offset:24576
  ds_read_b64_tr_b16 v[106:107], v17 offset:24576
  ds_read_b64_tr_b16 v[108:109], v10 offset:24832
  ds_read_b64_tr_b16 v[110:111], v11 offset:24832
  ds_read_b64_tr_b16 v[112:113], v12 offset:24832
  ds_read_b64_tr_b16 v[114:115], v13 offset:24832
  ds_read_b64_tr_b16 v[116:117], v14 offset:24832
  ds_read_b64_tr_b16 v[118:119], v15 offset:24832
  ds_read_b64_tr_b16 v[120:121], v16 offset:24832
  ds_read_b64_tr_b16 v[122:123], v17 offset:24832
  v_fma_f32 v124, v124, s96, -v18
  v_fma_f32 v125, v125, s96, -v18
  v_fma_f32 v126, v126, s96, -v18
  v_fma_f32 v127, v127, s96, -v18
  v_exp_f32 v124, v124
  v_exp_f32 v125, v125
  v_exp_f32 v126, v126
  v_exp_f32 v127, v127
  s_nop 0
  v_add_f32 v24, v124, v125
  v_add_f32 v25, v126, v127
  v_cvt_pk_bf16_f32 v124, v124, v125
  v_cvt_pk_bf16_f32 v125, v126, v127
  v_add_f32 v24, v24, v25
  v_add_f32 v19, v19, v24
  v_cndmask_b32 v44, 0, v124, s[48:49]
  v_cndmask_b32 v45, 0, v125, s[48:49]
  v_cndmask_b32 v46, 0, v124, s[50:51]
  v_cndmask_b32 v47, 0, v125, s[50:51]
  v_cndmask_b32 v48, 0, v124, s[52:53]
  v_cndmask_b32 v49, 0, v125, s[52:53]
  v_cndmask_b32 v50, 0, v124, s[54:55]
  v_cndmask_b32 v51, 0, v125, s[54:55]
  v_cndmask_b32 v52, 0, v124, s[56:57]
  v_cndmask_b32 v53, 0, v125, s[56:57]
  v_cndmask_b32 v54, 0, v124, s[58:59]
  v_cndmask_b32 v55, 0, v125, s[58:59]
  v_cndmask_b32 v56, 0, v124, s[60:61]
  v_cndmask_b32 v57, 0, v125, s[60:61]
  v_cndmask_b32 v58, 0, v124, s[62:63]
  v_cndmask_b32 v59, 0, v125, s[62:63]
  s_waitcnt lgkmcnt(0)
  s_waitcnt vmcnt(0)
  s_add_u32 m0, s42, 24576
  s_nop 0
  buffer_load_dwordx4 v2, s[28:31], s40 offen offset:0 nt lds
  buffer_load_dwordx4 v3, s[28:31], s40 offen offset:1024 nt lds
  buffer_load_dwordx4 v4, s[28:31], s40 offen offset:2048 nt lds
  buffer_load_dwordx4 v5, s[28:31], s40 offen offset:3072 nt lds
  s_add_u32 m0, s42, 28672
  s_nop 0
  buffer_load_dwordx4 v2, s[28:31], s41 offen offset:0 nt lds
  buffer_load_dwordx4 v3, s[28:31], s41 offen offset:1024 nt lds
  buffer_load_dwordx4 v4, s[28:31], s41 offen offset:2048 nt lds
  buffer_load_dwordx4 v5, s[28:31], s41 offen offset:3072 nt lds
  v_mfma_f32_16x16x16_bf16 v[36:39], v[92:93], v[44:45], v[36:39]
  v_mfma_f32_16x16x16_bf16 v[40:43], v[108:109], v[44:45], v[40:43]
  v_mfma_f32_16x16x16_bf16 v[36:39], v[94:95], v[46:47], v[36:39]
  v_mfma_f32_16x16x16_bf16 v[40:43], v[110:111], v[46:47], v[40:43]
  v_mfma_f32_16x16x16_bf16 v[36:39], v[96:97], v[48:49], v[36:39]
  v_mfma_f32_16x16x16_bf16 v[40:43], v[112:113], v[48:49], v[40:43]
  v_mfma_f32_16x16x16_bf16 v[36:39], v[98:99], v[50:51], v[36:39]
  v_mfma_f32_16x16x16_bf16 v[40:43], v[114:115], v[50:51], v[40:43]
  v_mfma_f32_16x16x16_bf16 v[36:39], v[100:101], v[52:53], v[36:39]
  v_mfma_f32_16x16x16_bf16 v[40:43], v[116:117], v[52:53], v[40:43]
  v_mfma_f32_16x16x16_bf16 v[36:39], v[102:103], v[54:55], v[36:39]
  v_mfma_f32_16x16x16_bf16 v[40:43], v[118:119], v[54:55], v[40:43]
  v_mfma_f32_16x16x16_bf16 v[36:39], v[104:105], v[56:57], v[36:39]
  v_mfma_f32_16x16x16_bf16 v[40:43], v[120:121], v[56:57], v[40:43]
  v_mfma_f32_16x16x16_bf16 v[36:39], v[106:107], v[58:59], v[36:39]
  v_mfma_f32_16x16x16_bf16 v[40:43], v[122:123], v[58:59], v[40:43]
  s_branch L_pool0_concat_heads__gqa_block_cached__gqa_block_cached__decode_kernel
L_tail0_concat_heads__gqa_block_cached__gqa_block_cached__decode_kernel:
  s_waitcnt vmcnt(24)
  ds_read_b128 v[92:95], v6 offset:0
  ds_read_b128 v[96:99], v7 offset:0
  ds_read_b128 v[100:103], v8 offset:0
  ds_read_b128 v[104:107], v9 offset:0
  ds_read_b128 v[108:111], v6 offset:256
  ds_read_b128 v[112:115], v7 offset:256
  ds_read_b128 v[116:119], v8 offset:256
  ds_read_b128 v[120:123], v9 offset:256
  s_waitcnt lgkmcnt(0)
  v_mfma_f32_16x16x32_bf16 v[124:127], v[92:95], v[60:63], 0
  v_mfma_f32_16x16x32_bf16 v[124:127], v[96:99], v[64:67], v[124:127]
  v_mfma_f32_16x16x32_bf16 v[124:127], v[100:103], v[68:71], v[124:127]
  v_mfma_f32_16x16x32_bf16 v[124:127], v[104:107], v[72:75], v[124:127]
  v_mfma_f32_16x16x32_bf16 v[124:127], v[108:111], v[76:79], v[124:127]
  v_mfma_f32_16x16x32_bf16 v[124:127], v[112:115], v[80:83], v[124:127]
  v_mfma_f32_16x16x32_bf16 v[124:127], v[116:119], v[84:87], v[124:127]
  v_mfma_f32_16x16x32_bf16 v[124:127], v[120:123], v[88:91], v[124:127]
  s_nop 7
  v_cvt_pk_bf16_f32 v26, v124, v125
  v_lshlrev_b32 v124, 16, v26
  v_and_b32 v125, 0xffff0000, v26
  v_cvt_pk_bf16_f32 v27, v126, v127
  v_lshlrev_b32 v126, 16, v27
  v_and_b32 v127, 0xffff0000, v27
  v_max3_f32 v252, v124, v125, v126
  v_max_f32 v252, v252, v127
  v_mov_b32 v21, v252
  v_mov_b32 v22, v252
  s_nop 1
  v_permlane16_swap_b32 v21, v22
  s_nop 1
  v_max_f32 v252, v21, v22
  v_mov_b32 v21, v252
  v_mov_b32 v22, v252
  s_nop 1
  v_permlane32_swap_b32 v21, v22
  s_nop 1
  v_max_f32 v252, v21, v22
  v_mul_f32 v20, s96, v252
  v_max_f32 v20, v20, v18
  v_sub_f32 v21, v18, v20
  v_exp_f32 v21, v21
  v_mov_b32 v18, v20
  v_mul_f32 v19, v19, v21
  v_mul_f32 v36, v36, v21
  v_mul_f32 v37, v37, v21
  v_mul_f32 v38, v38, v21
  v_mul_f32 v39, v39, v21
  v_mul_f32 v40, v40, v21
  v_mul_f32 v41, v41, v21
  v_mul_f32 v42, v42, v21
  v_mul_f32 v43, v43, v21
  s_waitcnt vmcnt(16)
  ds_read_b64_tr_b16 v[92:93], v10 offset:8192
  ds_read_b64_tr_b16 v[94:95], v11 offset:8192
  ds_read_b64_tr_b16 v[96:97], v12 offset:8192
  ds_read_b64_tr_b16 v[98:99], v13 offset:8192
  ds_read_b64_tr_b16 v[100:101], v14 offset:8192
  ds_read_b64_tr_b16 v[102:103], v15 offset:8192
  ds_read_b64_tr_b16 v[104:105], v16 offset:8192
  ds_read_b64_tr_b16 v[106:107], v17 offset:8192
  ds_read_b64_tr_b16 v[108:109], v10 offset:8448
  ds_read_b64_tr_b16 v[110:111], v11 offset:8448
  ds_read_b64_tr_b16 v[112:113], v12 offset:8448
  ds_read_b64_tr_b16 v[114:115], v13 offset:8448
  ds_read_b64_tr_b16 v[116:117], v14 offset:8448
  ds_read_b64_tr_b16 v[118:119], v15 offset:8448
  ds_read_b64_tr_b16 v[120:121], v16 offset:8448
  ds_read_b64_tr_b16 v[122:123], v17 offset:8448
  v_fma_f32 v124, v124, s96, -v18
  v_fma_f32 v125, v125, s96, -v18
  v_fma_f32 v126, v126, s96, -v18
  v_fma_f32 v127, v127, s96, -v18
  v_exp_f32 v124, v124
  v_exp_f32 v125, v125
  v_exp_f32 v126, v126
  v_exp_f32 v127, v127
  s_nop 0
  v_add_f32 v24, v124, v125
  v_add_f32 v25, v126, v127
  v_cvt_pk_bf16_f32 v124, v124, v125
  v_cvt_pk_bf16_f32 v125, v126, v127
  v_add_f32 v24, v24, v25
  v_add_f32 v19, v19, v24
  v_cndmask_b32 v44, 0, v124, s[48:49]
  v_cndmask_b32 v45, 0, v125, s[48:49]
  v_cndmask_b32 v46, 0, v124, s[50:51]
  v_cndmask_b32 v47, 0, v125, s[50:51]
  v_cndmask_b32 v48, 0, v124, s[52:53]
  v_cndmask_b32 v49, 0, v125, s[52:53]
  v_cndmask_b32 v50, 0, v124, s[54:55]
  v_cndmask_b32 v51, 0, v125, s[54:55]
  v_cndmask_b32 v52, 0, v124, s[56:57]
  v_cndmask_b32 v53, 0, v125, s[56:57]
  v_cndmask_b32 v54, 0, v124, s[58:59]
  v_cndmask_b32 v55, 0, v125, s[58:59]
  v_cndmask_b32 v56, 0, v124, s[60:61]
  v_cndmask_b32 v57, 0, v125, s[60:61]
  v_cndmask_b32 v58, 0, v124, s[62:63]
  v_cndmask_b32 v59, 0, v125, s[62:63]
  s_waitcnt lgkmcnt(0)
  v_mfma_f32_16x16x16_bf16 v[36:39], v[92:93], v[44:45], v[36:39]
  v_mfma_f32_16x16x16_bf16 v[40:43], v[108:109], v[44:45], v[40:43]
  v_mfma_f32_16x16x16_bf16 v[36:39], v[94:95], v[46:47], v[36:39]
  v_mfma_f32_16x16x16_bf16 v[40:43], v[110:111], v[46:47], v[40:43]
  v_mfma_f32_16x16x16_bf16 v[36:39], v[96:97], v[48:49], v[36:39]
  v_mfma_f32_16x16x16_bf16 v[40:43], v[112:113], v[48:49], v[40:43]
  v_mfma_f32_16x16x16_bf16 v[36:39], v[98:99], v[50:51], v[36:39]
  v_mfma_f32_16x16x16_bf16 v[40:43], v[114:115], v[50:51], v[40:43]
  v_mfma_f32_16x16x16_bf16 v[36:39], v[100:101], v[52:53], v[36:39]
  v_mfma_f32_16x16x16_bf16 v[40:43], v[116:117], v[52:53], v[40:43]
  v_mfma_f32_16x16x16_bf16 v[36:39], v[102:103], v[54:55], v[36:39]
  v_mfma_f32_16x16x16_bf16 v[40:43], v[118:119], v[54:55], v[40:43]
  v_mfma_f32_16x16x16_bf16 v[36:39], v[104:105], v[56:57], v[36:39]
  v_mfma_f32_16x16x16_bf16 v[40:43], v[120:121], v[56:57], v[40:43]
  v_mfma_f32_16x16x16_bf16 v[36:39], v[106:107], v[58:59], v[36:39]
  v_mfma_f32_16x16x16_bf16 v[40:43], v[122:123], v[58:59], v[40:43]
  s_waitcnt vmcnt(8)
  ds_read_b128 v[92:95], v6 offset:16384
  ds_read_b128 v[96:99], v7 offset:16384
  ds_read_b128 v[100:103], v8 offset:16384
  ds_read_b128 v[104:107], v9 offset:16384
  ds_read_b128 v[108:111], v6 offset:16640
  ds_read_b128 v[112:115], v7 offset:16640
  ds_read_b128 v[116:119], v8 offset:16640
  ds_read_b128 v[120:123], v9 offset:16640
  s_waitcnt lgkmcnt(0)
  v_mfma_f32_16x16x32_bf16 v[124:127], v[92:95], v[60:63], 0
  v_mfma_f32_16x16x32_bf16 v[124:127], v[96:99], v[64:67], v[124:127]
  v_mfma_f32_16x16x32_bf16 v[124:127], v[100:103], v[68:71], v[124:127]
  v_mfma_f32_16x16x32_bf16 v[124:127], v[104:107], v[72:75], v[124:127]
  v_mfma_f32_16x16x32_bf16 v[124:127], v[108:111], v[76:79], v[124:127]
  v_mfma_f32_16x16x32_bf16 v[124:127], v[112:115], v[80:83], v[124:127]
  v_mfma_f32_16x16x32_bf16 v[124:127], v[116:119], v[84:87], v[124:127]
  v_mfma_f32_16x16x32_bf16 v[124:127], v[120:123], v[88:91], v[124:127]
  s_nop 7
  v_cvt_pk_bf16_f32 v26, v124, v125
  v_lshlrev_b32 v124, 16, v26
  v_and_b32 v125, 0xffff0000, v26
  v_cvt_pk_bf16_f32 v27, v126, v127
  v_lshlrev_b32 v126, 16, v27
  v_and_b32 v127, 0xffff0000, v27
  v_max3_f32 v252, v124, v125, v126
  v_max_f32 v252, v252, v127
  v_mov_b32 v21, v252
  v_mov_b32 v22, v252
  s_nop 1
  v_permlane16_swap_b32 v21, v22
  s_nop 1
  v_max_f32 v252, v21, v22
  v_mov_b32 v21, v252
  v_mov_b32 v22, v252
  s_nop 1
  v_permlane32_swap_b32 v21, v22
  s_nop 1
  v_max_f32 v252, v21, v22
  v_mul_f32 v20, s96, v252
  v_max_f32 v20, v20, v18
  v_sub_f32 v21, v18, v20
  v_exp_f32 v21, v21
  v_mov_b32 v18, v20
  v_mul_f32 v19, v19, v21
  v_mul_f32 v36, v36, v21
  v_mul_f32 v37, v37, v21
  v_mul_f32 v38, v38, v21
  v_mul_f32 v39, v39, v21
  v_mul_f32 v40, v40, v21
  v_mul_f32 v41, v41, v21
  v_mul_f32 v42, v42, v21
  v_mul_f32 v43, v43, v21
  s_waitcnt vmcnt(0)
  ds_read_b64_tr_b16 v[92:93], v10 offset:24576
  ds_read_b64_tr_b16 v[94:95], v11 offset:24576
  ds_read_b64_tr_b16 v[96:97], v12 offset:24576
  ds_read_b64_tr_b16 v[98:99], v13 offset:24576
  ds_read_b64_tr_b16 v[100:101], v14 offset:24576
  ds_read_b64_tr_b16 v[102:103], v15 offset:24576
  ds_read_b64_tr_b16 v[104:105], v16 offset:24576
  ds_read_b64_tr_b16 v[106:107], v17 offset:24576
  ds_read_b64_tr_b16 v[108:109], v10 offset:24832
  ds_read_b64_tr_b16 v[110:111], v11 offset:24832
  ds_read_b64_tr_b16 v[112:113], v12 offset:24832
  ds_read_b64_tr_b16 v[114:115], v13 offset:24832
  ds_read_b64_tr_b16 v[116:117], v14 offset:24832
  ds_read_b64_tr_b16 v[118:119], v15 offset:24832
  ds_read_b64_tr_b16 v[120:121], v16 offset:24832
  ds_read_b64_tr_b16 v[122:123], v17 offset:24832
  v_fma_f32 v124, v124, s96, -v18
  v_fma_f32 v125, v125, s96, -v18
  v_fma_f32 v126, v126, s96, -v18
  v_fma_f32 v127, v127, s96, -v18
  v_exp_f32 v124, v124
  v_exp_f32 v125, v125
  v_exp_f32 v126, v126
  v_exp_f32 v127, v127
  s_nop 0
  v_add_f32 v24, v124, v125
  v_add_f32 v25, v126, v127
  v_cvt_pk_bf16_f32 v124, v124, v125
  v_cvt_pk_bf16_f32 v125, v126, v127
  v_add_f32 v24, v24, v25
  v_add_f32 v19, v19, v24
  v_cndmask_b32 v44, 0, v124, s[48:49]
  v_cndmask_b32 v45, 0, v125, s[48:49]
  v_cndmask_b32 v46, 0, v124, s[50:51]
  v_cndmask_b32 v47, 0, v125, s[50:51]
  v_cndmask_b32 v48, 0, v124, s[52:53]
  v_cndmask_b32 v49, 0, v125, s[52:53]
  v_cndmask_b32 v50, 0, v124, s[54:55]
  v_cndmask_b32 v51, 0, v125, s[54:55]
  v_cndmask_b32 v52, 0, v124, s[56:57]
  v_cndmask_b32 v53, 0, v125, s[56:57]
  v_cndmask_b32 v54, 0, v124, s[58:59]
  v_cndmask_b32 v55, 0, v125, s[58:59]
  v_cndmask_b32 v56, 0, v124, s[60:61]
  v_cndmask_b32 v57, 0, v125, s[60:61]
  v_cndmask_b32 v58, 0, v124, s[62:63]
  v_cndmask_b32 v59, 0, v125, s[62:63]
  s_waitcnt lgkmcnt(0)
  v_mfma_f32_16x16x16_bf16 v[36:39], v[92:93], v[44:45], v[36:39]
  v_mfma_f32_16x16x16_bf16 v[40:43], v[108:109], v[44:45], v[40:43]
  v_mfma_f32_16x16x16_bf16 v[36:39], v[94:95], v[46:47], v[36:39]
  v_mfma_f32_16x16x16_bf16 v[40:43], v[110:111], v[46:47], v[40:43]
  v_mfma_f32_16x16x16_bf16 v[36:39], v[96:97], v[48:49], v[36:39]
  v_mfma_f32_16x16x16_bf16 v[40:43], v[112:113], v[48:49], v[40:43]
  v_mfma_f32_16x16x16_bf16 v[36:39], v[98:99], v[50:51], v[36:39]
  v_mfma_f32_16x16x16_bf16 v[40:43], v[114:115], v[50:51], v[40:43]
  v_mfma_f32_16x16x16_bf16 v[36:39], v[100:101], v[52:53], v[36:39]
  v_mfma_f32_16x16x16_bf16 v[40:43], v[116:117], v[52:53], v[40:43]
  v_mfma_f32_16x16x16_bf16 v[36:39], v[102:103], v[54:55], v[36:39]
  v_mfma_f32_16x16x16_bf16 v[40:43], v[118:119], v[54:55], v[40:43]
  v_mfma_f32_16x16x16_bf16 v[36:39], v[104:105], v[56:57], v[36:39]
  v_mfma_f32_16x16x16_bf16 v[40:43], v[120:121], v[56:57], v[40:43]
  v_mfma_f32_16x16x16_bf16 v[36:39], v[106:107], v[58:59], v[36:39]
  v_mfma_f32_16x16x16_bf16 v[40:43], v[122:123], v[58:59], v[40:43]
  s_branch L_sdone_concat_heads__gqa_block_cached__gqa_block_cached__decode_kernel
L_tail1_concat_heads__gqa_block_cached__gqa_block_cached__decode_kernel:
  s_waitcnt vmcnt(24)
  ds_read_b128 v[92:95], v6 offset:16384
  ds_read_b128 v[96:99], v7 offset:16384
  ds_read_b128 v[100:103], v8 offset:16384
  ds_read_b128 v[104:107], v9 offset:16384
  ds_read_b128 v[108:111], v6 offset:16640
  ds_read_b128 v[112:115], v7 offset:16640
  ds_read_b128 v[116:119], v8 offset:16640
  ds_read_b128 v[120:123], v9 offset:16640
  s_waitcnt lgkmcnt(0)
  v_mfma_f32_16x16x32_bf16 v[124:127], v[92:95], v[60:63], 0
  v_mfma_f32_16x16x32_bf16 v[124:127], v[96:99], v[64:67], v[124:127]
  v_mfma_f32_16x16x32_bf16 v[124:127], v[100:103], v[68:71], v[124:127]
  v_mfma_f32_16x16x32_bf16 v[124:127], v[104:107], v[72:75], v[124:127]
  v_mfma_f32_16x16x32_bf16 v[124:127], v[108:111], v[76:79], v[124:127]
  v_mfma_f32_16x16x32_bf16 v[124:127], v[112:115], v[80:83], v[124:127]
  v_mfma_f32_16x16x32_bf16 v[124:127], v[116:119], v[84:87], v[124:127]
  v_mfma_f32_16x16x32_bf16 v[124:127], v[120:123], v[88:91], v[124:127]
  s_nop 7
  v_cvt_pk_bf16_f32 v26, v124, v125
  v_lshlrev_b32 v124, 16, v26
  v_and_b32 v125, 0xffff0000, v26
  v_cvt_pk_bf16_f32 v27, v126, v127
  v_lshlrev_b32 v126, 16, v27
  v_and_b32 v127, 0xffff0000, v27
  v_max3_f32 v252, v124, v125, v126
  v_max_f32 v252, v252, v127
  v_mov_b32 v21, v252
  v_mov_b32 v22, v252
  s_nop 1
  v_permlane16_swap_b32 v21, v22
  s_nop 1
  v_max_f32 v252, v21, v22
  v_mov_b32 v21, v252
  v_mov_b32 v22, v252
  s_nop 1
  v_permlane32_swap_b32 v21, v22
  s_nop 1
  v_max_f32 v252, v21, v22
  v_mul_f32 v20, s96, v252
  v_max_f32 v20, v20, v18
  v_sub_f32 v21, v18, v20
  v_exp_f32 v21, v21
  v_mov_b32 v18, v20
  v_mul_f32 v19, v19, v21
  v_mul_f32 v36, v36, v21
  v_mul_f32 v37, v37, v21
  v_mul_f32 v38, v38, v21
  v_mul_f32 v39, v39, v21
  v_mul_f32 v40, v40, v21
  v_mul_f32 v41, v41, v21
  v_mul_f32 v42, v42, v21
  v_mul_f32 v43, v43, v21
  s_waitcnt vmcnt(16)
  ds_read_b64_tr_b16 v[92:93], v10 offset:24576
  ds_read_b64_tr_b16 v[94:95], v11 offset:24576
  ds_read_b64_tr_b16 v[96:97], v12 offset:24576
  ds_read_b64_tr_b16 v[98:99], v13 offset:24576
  ds_read_b64_tr_b16 v[100:101], v14 offset:24576
  ds_read_b64_tr_b16 v[102:103], v15 offset:24576
  ds_read_b64_tr_b16 v[104:105], v16 offset:24576
  ds_read_b64_tr_b16 v[106:107], v17 offset:24576
  ds_read_b64_tr_b16 v[108:109], v10 offset:24832
  ds_read_b64_tr_b16 v[110:111], v11 offset:24832
  ds_read_b64_tr_b16 v[112:113], v12 offset:24832
  ds_read_b64_tr_b16 v[114:115], v13 offset:24832
  ds_read_b64_tr_b16 v[116:117], v14 offset:24832
  ds_read_b64_tr_b16 v[118:119], v15 offset:24832
  ds_read_b64_tr_b16 v[120:121], v16 offset:24832
  ds_read_b64_tr_b16 v[122:123], v17 offset:24832
  v_fma_f32 v124, v124, s96, -v18
  v_fma_f32 v125, v125, s96, -v18
  v_fma_f32 v126, v126, s96, -v18
  v_fma_f32 v127, v127, s96, -v18
  v_exp_f32 v124, v124
  v_exp_f32 v125, v125
  v_exp_f32 v126, v126
  v_exp_f32 v127, v127
  s_nop 0
  v_add_f32 v24, v124, v125
  v_add_f32 v25, v126, v127
  v_cvt_pk_bf16_f32 v124, v124, v125
  v_cvt_pk_bf16_f32 v125, v126, v127
  v_add_f32 v24, v24, v25
  v_add_f32 v19, v19, v24
  v_cndmask_b32 v44, 0, v124, s[48:49]
  v_cndmask_b32 v45, 0, v125, s[48:49]
  v_cndmask_b32 v46, 0, v124, s[50:51]
  v_cndmask_b32 v47, 0, v125, s[50:51]
  v_cndmask_b32 v48, 0, v124, s[52:53]
  v_cndmask_b32 v49, 0, v125, s[52:53]
  v_cndmask_b32 v50, 0, v124, s[54:55]
  v_cndmask_b32 v51, 0, v125, s[54:55]
  v_cndmask_b32 v52, 0, v124, s[56:57]
  v_cndmask_b32 v53, 0, v125, s[56:57]
  v_cndmask_b32 v54, 0, v124, s[58:59]
  v_cndmask_b32 v55, 0, v125, s[58:59]
  v_cndmask_b32 v56, 0, v124, s[60:61]
  v_cndmask_b32 v57, 0, v125, s[60:61]
  v_cndmask_b32 v58, 0, v124, s[62:63]
  v_cndmask_b32 v59, 0, v125, s[62:63]
  s_waitcnt lgkmcnt(0)
  v_mfma_f32_16x16x16_bf16 v[36:39], v[92:93], v[44:45], v[36:39]
  v_mfma_f32_16x16x16_bf16 v[40:43], v[108:109], v[44:45], v[40:43]
  v_mfma_f32_16x16x16_bf16 v[36:39], v[94:95], v[46:47], v[36:39]
  v_mfma_f32_16x16x16_bf16 v[40:43], v[110:111], v[46:47], v[40:43]
  v_mfma_f32_16x16x16_bf16 v[36:39], v[96:97], v[48:49], v[36:39]
  v_mfma_f32_16x16x16_bf16 v[40:43], v[112:113], v[48:49], v[40:43]
  v_mfma_f32_16x16x16_bf16 v[36:39], v[98:99], v[50:51], v[36:39]
  v_mfma_f32_16x16x16_bf16 v[40:43], v[114:115], v[50:51], v[40:43]
  v_mfma_f32_16x16x16_bf16 v[36:39], v[100:101], v[52:53], v[36:39]
  v_mfma_f32_16x16x16_bf16 v[40:43], v[116:117], v[52:53], v[40:43]
  v_mfma_f32_16x16x16_bf16 v[36:39], v[102:103], v[54:55], v[36:39]
  v_mfma_f32_16x16x16_bf16 v[40:43], v[118:119], v[54:55], v[40:43]
  v_mfma_f32_16x16x16_bf16 v[36:39], v[104:105], v[56:57], v[36:39]
  v_mfma_f32_16x16x16_bf16 v[40:43], v[120:121], v[56:57], v[40:43]
  v_mfma_f32_16x16x16_bf16 v[36:39], v[106:107], v[58:59], v[36:39]
  v_mfma_f32_16x16x16_bf16 v[40:43], v[122:123], v[58:59], v[40:43]
  s_waitcnt vmcnt(8)
  ds_read_b128 v[92:95], v6 offset:0
  ds_read_b128 v[96:99], v7 offset:0
  ds_read_b128 v[100:103], v8 offset:0
  ds_read_b128 v[104:107], v9 offset:0
  ds_read_b128 v[108:111], v6 offset:256
  ds_read_b128 v[112:115], v7 offset:256
  ds_read_b128 v[116:119], v8 offset:256
  ds_read_b128 v[120:123], v9 offset:256
  s_waitcnt lgkmcnt(0)
  v_mfma_f32_16x16x32_bf16 v[124:127], v[92:95], v[60:63], 0
  v_mfma_f32_16x16x32_bf16 v[124:127], v[96:99], v[64:67], v[124:127]
  v_mfma_f32_16x16x32_bf16 v[124:127], v[100:103], v[68:71], v[124:127]
  v_mfma_f32_16x16x32_bf16 v[124:127], v[104:107], v[72:75], v[124:127]
  v_mfma_f32_16x16x32_bf16 v[124:127], v[108:111], v[76:79], v[124:127]
  v_mfma_f32_16x16x32_bf16 v[124:127], v[112:115], v[80:83], v[124:127]
  v_mfma_f32_16x16x32_bf16 v[124:127], v[116:119], v[84:87], v[124:127]
  v_mfma_f32_16x16x32_bf16 v[124:127], v[120:123], v[88:91], v[124:127]
  s_nop 7
  v_cvt_pk_bf16_f32 v26, v124, v125
  v_lshlrev_b32 v124, 16, v26
  v_and_b32 v125, 0xffff0000, v26
  v_cvt_pk_bf16_f32 v27, v126, v127
  v_lshlrev_b32 v126, 16, v27
  v_and_b32 v127, 0xffff0000, v27
  v_max3_f32 v252, v124, v125, v126
  v_max_f32 v252, v252, v127
  v_mov_b32 v21, v252
  v_mov_b32 v22, v252
  s_nop 1
  v_permlane16_swap_b32 v21, v22
  s_nop 1
  v_max_f32 v252, v21, v22
  v_mov_b32 v21, v252
  v_mov_b32 v22, v252
  s_nop 1
  v_permlane32_swap_b32 v21, v22
  s_nop 1
  v_max_f32 v252, v21, v22
  v_mul_f32 v20, s96, v252
  v_max_f32 v20, v20, v18
  v_sub_f32 v21, v18, v20
  v_exp_f32 v21, v21
  v_mov_b32 v18, v20
  v_mul_f32 v19, v19, v21
  v_mul_f32 v36, v36, v21
  v_mul_f32 v37, v37, v21
  v_mul_f32 v38, v38, v21
  v_mul_f32 v39, v39, v21
  v_mul_f32 v40, v40, v21
  v_mul_f32 v41, v41, v21
  v_mul_f32 v42, v42, v21
  v_mul_f32 v43, v43, v21
  s_waitcnt vmcnt(0)
  ds_read_b64_tr_b16 v[92:93], v10 offset:8192
  ds_read_b64_tr_b16 v[94:95], v11 offset:8192
  ds_read_b64_tr_b16 v[96:97], v12 offset:8192
  ds_read_b64_tr_b16 v[98:99], v13 offset:8192
  ds_read_b64_tr_b16 v[100:101], v14 offset:8192
  ds_read_b64_tr_b16 v[102:103], v15 offset:8192
  ds_read_b64_tr_b16 v[104:105], v16 offset:8192
  ds_read_b64_tr_b16 v[106:107], v17 offset:8192
  ds_read_b64_tr_b16 v[108:109], v10 offset:8448
  ds_read_b64_tr_b16 v[110:111], v11 offset:8448
  ds_read_b64_tr_b16 v[112:113], v12 offset:8448
  ds_read_b64_tr_b16 v[114:115], v13 offset:8448
  ds_read_b64_tr_b16 v[116:117], v14 offset:8448
  ds_read_b64_tr_b16 v[118:119], v15 offset:8448
  ds_read_b64_tr_b16 v[120:121], v16 offset:8448
  ds_read_b64_tr_b16 v[122:123], v17 offset:8448
  v_fma_f32 v124, v124, s96, -v18
  v_fma_f32 v125, v125, s96, -v18
  v_fma_f32 v126, v126, s96, -v18
  v_fma_f32 v127, v127, s96, -v18
  v_exp_f32 v124, v124
  v_exp_f32 v125, v125
  v_exp_f32 v126, v126
  v_exp_f32 v127, v127
  s_nop 0
  v_add_f32 v24, v124, v125
  v_add_f32 v25, v126, v127
  v_cvt_pk_bf16_f32 v124, v124, v125
  v_cvt_pk_bf16_f32 v125, v126, v127
  v_add_f32 v24, v24, v25
  v_add_f32 v19, v19, v24
  v_cndmask_b32 v44, 0, v124, s[48:49]
  v_cndmask_b32 v45, 0, v125, s[48:49]
  v_cndmask_b32 v46, 0, v124, s[50:51]
  v_cndmask_b32 v47, 0, v125, s[50:51]
  v_cndmask_b32 v48, 0, v124, s[52:53]
  v_cndmask_b32 v49, 0, v125, s[52:53]
  v_cndmask_b32 v50, 0, v124, s[54:55]
  v_cndmask_b32 v51, 0, v125, s[54:55]
  v_cndmask_b32 v52, 0, v124, s[56:57]
  v_cndmask_b32 v53, 0, v125, s[56:57]
  v_cndmask_b32 v54, 0, v124, s[58:59]
  v_cndmask_b32 v55, 0, v125, s[58:59]
  v_cndmask_b32 v56, 0, v124, s[60:61]
  v_cndmask_b32 v57, 0, v125, s[60:61]
  v_cndmask_b32 v58, 0, v124, s[62:63]
  v_cndmask_b32 v59, 0, v125, s[62:63]
  s_waitcnt lgkmcnt(0)
  v_mfma_f32_16x16x16_bf16 v[36:39], v[92:93], v[44:45], v[36:39]
  v_mfma_f32_16x16x16_bf16 v[40:43], v[108:109], v[44:45], v[40:43]
  v_mfma_f32_16x16x16_bf16 v[36:39], v[94:95], v[46:47], v[36:39]
  v_mfma_f32_16x16x16_bf16 v[40:43], v[110:111], v[46:47], v[40:43]
  v_mfma_f32_16x16x16_bf16 v[36:39], v[96:97], v[48:49], v[36:39]
  v_mfma_f32_16x16x16_bf16 v[40:43], v[112:113], v[48:49], v[40:43]
  v_mfma_f32_16x16x16_bf16 v[36:39], v[98:99], v[50:51], v[36:39]
  v_mfma_f32_16x16x16_bf16 v[40:43], v[114:115], v[50:51], v[40:43]
  v_mfma_f32_16x16x16_bf16 v[36:39], v[100:101], v[52:53], v[36:39]
  v_mfma_f32_16x16x16_bf16 v[40:43], v[116:117], v[52:53], v[40:43]
  v_mfma_f32_16x16x16_bf16 v[36:39], v[102:103], v[54:55], v[36:39]
  v_mfma_f32_16x16x16_bf16 v[40:43], v[118:119], v[54:55], v[40:43]
  v_mfma_f32_16x16x16_bf16 v[36:39], v[104:105], v[56:57], v[36:39]
  v_mfma_f32_16x16x16_bf16 v[40:43], v[120:121], v[56:57], v[40:43]
  v_mfma_f32_16x16x16_bf16 v[36:39], v[106:107], v[58:59], v[36:39]
  v_mfma_f32_16x16x16_bf16 v[40:43], v[122:123], v[58:59], v[40:43]
L_sdone_concat_heads__gqa_block_cached__gqa_block_cached__decode_kernel:
  v_mov_b32 v21, v19
  v_mov_b32 v22, v19
  s_nop 1
  v_permlane16_swap_b32 v21, v22
  s_nop 1
  v_add_f32 v19, v21, v22
  v_mov_b32 v21, v19
  v_mov_b32 v22, v19
  s_nop 1
  v_permlane32_swap_b32 v21, v22
  s_nop 1
  v_add_f32 v19, v21, v22
  v_lshlrev_b32 v20, 4, v1
  v_add_u32 v20, s42, v20
  v_and_b32 v21, 1, v1
  v_lshlrev_b32 v21, 3, v21
  v_add_u32 v21, s42, v21
  v_mov_b32 v22, v18
  v_mov_b32 v23, v19
  s_nop 4
  ds_write_b128 v20, v[36:39]
  ds_write_b128 v20, v[40:43] offset:1024
  ds_write_b64 v21, v[22:23] offset:2048
  s_waitcnt lgkmcnt(0)
  s_barrier
  s_and_b32 s43, s3, 1
  s_lshl_b32 s43, s43, 10
  s_lshr_b32 s44, s3, 1
  v_bfe_u32 v20, v1, 1, 2
  v_lshlrev_b32 v20, 8, v20
  v_lshrrev_b32 v21, 3, v1
  v_lshl_add_u32 v20, v21, 5, v20
  v_and_b32 v21, 1, v1
  v_lshl_add_u32 v20, v21, 3, v20
  s_lshl_b32 s45, s44, 4
  s_add_u32 s45, s45, s43
  v_add_u32 v20, s45, v20
  v_add_u32 v22, 65536, v20
  s_lshl_b32 s45, s44, 3
  v_mov_b32 v21, s45
  v_add_u32 v23, 65536, v21
  ds_read_b64 v[92:93], v20 offset:0
  ds_read_b64 v[100:101], v21 offset:2048
  ds_read_b64 v[94:95], v20 offset:32768
  ds_read_b64 v[102:103], v21 offset:34816
  ds_read_b64 v[96:97], v22 offset:0
  ds_read_b64 v[104:105], v23 offset:2048
  ds_read_b64 v[98:99], v22 offset:32768
  ds_read_b64 v[106:107], v23 offset:34816
  v_lshlrev_b32 v24, 4, v1
  s_mul_i32 s97, s2, 4608
  s_add_u32 s97, s97, 589824
  s_lshl_b32 s44, s44, 11
  s_add_u32 s44, s44, s43
  s_add_u32 s44, s44, s97
  s_waitcnt lgkmcnt(0)
  v_max3_f32 v220, v100, v102, v104
  v_max_f32 v220, v220, v106
  v_sub_f32 v100, v100, v220
  v_sub_f32 v102, v102, v220
  v_sub_f32 v104, v104, v220
  v_sub_f32 v106, v106, v220
  v_exp_f32 v100, v100
  v_exp_f32 v102, v102
  v_exp_f32 v104, v104
  v_exp_f32 v106, v106
  v_mov_b32 v225, s22
  v_mov_b32 v227, s22
  v_mul_f32 v224, v100, v92
  v_fma_f32 v224, v102, v94, v224
  v_fma_f32 v224, v104, v96, v224
  v_fma_f32 v224, v106, v98, v224
  v_mul_f32 v226, v100, v93
  v_fma_f32 v226, v102, v95, v226
  v_fma_f32 v226, v104, v97, v226
  v_fma_f32 v226, v106, v99, v226
  buffer_store_dwordx4 v[224:227], v24, s[36:39], s44 offen sc1
  s_and_b32 s43, s3, 1
  s_cmp_lg_u32 s43, 0
  s_cbranch_scc1 Lnost_concat_heads__gqa_block_cached__gqa_block_cached__decode_kernel_4
  v_mul_f32 v222, v100, v101
  v_fma_f32 v222, v102, v103, v222
  v_fma_f32 v222, v104, v105, v222
  v_fma_f32 v222, v106, v107, v222
  v_mov_b32 v221, s22
  v_mov_b32 v223, s22
  v_mov_b32 v23, 0
  s_lshl_b32 s43, s3, 3
  s_add_u32 s97, s97, s43
  s_add_u32 s97, s97, 4096
  s_mov_b64 s[72:73], exec
  s_mov_b64 exec, 1
  buffer_store_dwordx4 v[220:223], v23, s[36:39], s97 offen sc1
  s_mov_b64 exec, s[72:73]
Lnost_concat_heads__gqa_block_cached__gqa_block_cached__decode_kernel_4:
  v_lshrrev_b32 v20, 4, v1
  v_and_b32 v21, 15, v1
  v_lshrrev_b32 v22, 2, v21
  v_and_b32 v23, 3, v21
  v_lshl_add_u32 v22, v20, 3, v22
  v_mul_u32_u24 v22, 896, v22
  v_lshl_add_u32 v22, v23, 3, v22
  s_mul_i32 s43, s3, 224
  s_add_u32 s43, s43, 131072
  v_add_u32 v22, s43, v22
  ds_read_b64_tr_b16 v[60:61], v22 offset:0
  ds_read_b64_tr_b16 v[62:63], v22 offset:3584
  ds_read_b64_tr_b16 v[64:65], v22 offset:32
  ds_read_b64_tr_b16 v[66:67], v22 offset:3616
  ds_read_b64_tr_b16 v[68:69], v22 offset:64
  ds_read_b64_tr_b16 v[70:71], v22 offset:3648
  ds_read_b64_tr_b16 v[72:73], v22 offset:96
  ds_read_b64_tr_b16 v[74:75], v22 offset:3680
  ds_read_b64_tr_b16 v[76:77], v22 offset:128
  ds_read_b64_tr_b16 v[78:79], v22 offset:3712
  ds_read_b64_tr_b16 v[80:81], v22 offset:160
  ds_read_b64_tr_b16 v[82:83], v22 offset:3744
  ds_read_b64_tr_b16 v[84:85], v22 offset:192
  ds_read_b64_tr_b16 v[86:87], v22 offset:3776
  s_mul_i32 s43, s4, 28
  s_mul_i32 s44, s3, 7
  s_add_u32 s43, s43, s44
  s_lshl_b32 s43, s43, 7
  s_lshl_b32 s44, s70, 4
  s_add_u32 s44, s44, s7
  s_add_u32 s43, s43, s44
  s_lshl_b32 s43, s43, 9
  s_add_u32 s43, s43, 2097152
  v_lshrrev_b32 v24, 3, v21
  v_lshlrev_b32 v24, 16, v24
  v_lshl_add_u32 v24, v23, 7, v24
  v_lshl_add_u32 v24, v20, 5, v24
  v_bfe_u32 v25, v21, 2, 1
  v_lshl_add_u32 v24, v25, 4, v24
  v_mov_b32 v45, s22
  v_mov_b32 v47, s22
  v_mov_b32 v49, s22
  v_mov_b32 v51, s22
  v_mov_b32 v53, s22
  v_mov_b32 v55, s22
  v_mov_b32 v57, s22
  v_mov_b32 v59, s22
  s_mov_b32 s48, 0xf0f0f0f0
  s_mov_b32 s49, 0xf0f0f0f0
  s_mov_b32 s50, 0xff00ff00
  s_mov_b32 s51, 0xff00ff00
  v_lshlrev_b32 v20, 4, v1
  v_add_u32 v20, 159744, v20
  s_waitcnt lgkmcnt(0)
  s_barrier
  ds_read_b128 v[220:223], v20
  s_waitcnt lgkmcnt(0)
  v_mfma_f32_16x16x32_bf16 v[124:127], v[60:63], v[220:223], 0
  v_mfma_f32_16x16x32_bf16 v[128:131], v[64:67], v[220:223], 0
  v_mfma_f32_16x16x32_bf16 v[132:135], v[68:71], v[220:223], 0
  v_mfma_f32_16x16x32_bf16 v[136:139], v[72:75], v[220:223], 0
  v_mfma_f32_16x16x32_bf16 v[140:143], v[76:79], v[220:223], 0
  v_mfma_f32_16x16x32_bf16 v[144:147], v[80:83], v[220:223], 0
  v_mfma_f32_16x16x32_bf16 v[148:151], v[84:87], v[220:223], 0
  s_nop 1
  v_cndmask_b32 v26, v124, v126, s[48:49]
  v_cndmask_b32 v27, v128, v130, s[48:49]
  v_cndmask_b32 v44, v26, v27, s[50:51]
  v_cndmask_b32 v26, v125, v127, s[48:49]
  v_cndmask_b32 v27, v129, v131, s[48:49]
  v_cndmask_b32 v46, v26, v27, s[50:51]
  buffer_store_dwordx4 v[44:47], v24, s[36:39], s43 offen sc1
  s_add_u32 s43, s43, 131072
  v_cndmask_b32 v26, v132, v134, s[48:49]
  v_cndmask_b32 v27, v136, v138, s[48:49]
  v_cndmask_b32 v48, v26, v27, s[50:51]
  v_cndmask_b32 v26, v133, v135, s[48:49]
  v_cndmask_b32 v27, v137, v139, s[48:49]
  v_cndmask_b32 v50, v26, v27, s[50:51]
  buffer_store_dwordx4 v[48:51], v24, s[36:39], s43 offen sc1
  s_add_u32 s43, s43, 131072
  v_cndmask_b32 v26, v140, v142, s[48:49]
  v_cndmask_b32 v27, v144, v146, s[48:49]
  v_cndmask_b32 v52, v26, v27, s[50:51]
  v_cndmask_b32 v26, v141, v143, s[48:49]
  v_cndmask_b32 v27, v145, v147, s[48:49]
  v_cndmask_b32 v54, v26, v27, s[50:51]
  buffer_store_dwordx4 v[52:55], v24, s[36:39], s43 offen sc1
  s_add_u32 s43, s43, 131072
  s_nop 4
  v_cndmask_b32 v56, v148, v150, s[48:49]
  v_cndmask_b32 v58, v149, v151, s[48:49]
  s_mov_b64 s[72:73], exec
  s_mov_b32 exec_lo, 0x00ff00ff
  s_mov_b32 exec_hi, 0x00ff00ff
  buffer_store_dwordx4 v[56:59], v24, s[36:39], s43 offen sc1
  s_add_u32 s43, s43, 131072
  s_mov_b64 exec, s[72:73]
  s_branch L_end_concat_heads__gqa_block_cached__gqa_block_cached__decode_kernel
L_cw_concat_heads__gqa_block_cached__gqa_block_cached__decode_kernel:
  v_lshlrev_b32 v20, 2, v1
  v_add_u32 v20, 160768, v20
  v_mov_b32 v21, 0
  ds_write_b32 v20, v21
  s_cmp_lg_u32 s6, 0
  s_cbranch_scc1 Lnc_concat_heads__gqa_block_cached__gqa_block_cached__decode_kernel_5
  s_lshl_b32 s43, s68, 8
  s_add_u32 s43, s43, 4096
  v_mov_b32 v22, 0
  s_mov_b64 s[72:73], exec
  s_mov_b64 exec, 1
  buffer_store_dword v21, v22, s[36:39], s43 offen sc1
  s_mov_b64 exec, s[72:73]
Lnc_concat_heads__gqa_block_cached__gqa_block_cached__decode_kernel_5:
  s_mov_b32 s32, s8
  s_mov_b32 s33, s9
  s_mov_b32 s34, 3584
  s_mov_b32 s35, 0x20000
  v_and_b32 v20, 3, v1
  v_mul_u32_u24 v20, 896, v20
  v_lshrrev_b32 v21, 4, v1
  v_lshl_add_u32 v20, v21, 4, v20
  buffer_load_dwordx4 v[60:63], v20, s[32:35], 0 offen offset:0
  buffer_load_dwordx4 v[64:67], v20, s[32:35], 0 offen offset:64
  buffer_load_dwordx4 v[68:71], v20, s[32:35], 0 offen offset:128
  buffer_load_dwordx4 v[72:75], v20, s[32:35], 0 offen offset:192
  buffer_load_dwordx4 v[76:79], v20, s[32:35], 0 offen offset:256
  buffer_load_dwordx4 v[80:83], v20, s[32:35], 0 offen offset:320
  buffer_load_dwordx4 v[84:87], v20, s[32:35], 0 offen offset:384
  buffer_load_dwordx4 v[88:91], v20, s[32:35], 0 offen offset:448
  buffer_load_dwordx4 v[92:95], v20, s[32:35], 0 offen offset:512
  buffer_load_dwordx4 v[96:99], v20, s[32:35], 0 offen offset:576
  buffer_load_dwordx4 v[100:103], v20, s[32:35], 0 offen offset:640
  buffer_load_dwordx4 v[104:107], v20, s[32:35], 0 offen offset:704
  buffer_load_dwordx4 v[108:111], v20, s[32:35], 0 offen offset:768
  buffer_load_dwordx4 v[112:115], v20, s[32:35], 0 offen offset:832
  s_waitcnt lgkmcnt(0)
  s_barrier
  v_and_b32 v22, 15, v1
  v_lshrrev_b32 v23, 2, v22
  v_and_b32 v24, 3, v22
  v_lshl_add_u32 v23, v21, 3, v23
  v_lshlrev_b32 v23, 6, v23
  v_lshl_add_u32 v23, v24, 3, v23
  v_add_u32 v23, 131072, v23
  ds_read_b64_tr_b16 v[116:117], v23 offset:0
  ds_read_b64_tr_b16 v[118:119], v23 offset:256
  ds_read_b64_tr_b16 v[120:121], v23 offset:2048
  ds_read_b64_tr_b16 v[122:123], v23 offset:2304
  ds_read_b64_tr_b16 v[124:125], v23 offset:4096
  ds_read_b64_tr_b16 v[126:127], v23 offset:4352
  ds_read_b64_tr_b16 v[128:129], v23 offset:6144
  ds_read_b64_tr_b16 v[130:131], v23 offset:6400
  ds_read_b64_tr_b16 v[132:133], v23 offset:8192
  ds_read_b64_tr_b16 v[134:135], v23 offset:8448
  ds_read_b64_tr_b16 v[136:137], v23 offset:10240
  ds_read_b64_tr_b16 v[138:139], v23 offset:10496
  ds_read_b64_tr_b16 v[140:141], v23 offset:12288
  ds_read_b64_tr_b16 v[142:143], v23 offset:12544
  ds_read_b64_tr_b16 v[144:145], v23 offset:14336
  ds_read_b64_tr_b16 v[146:147], v23 offset:14592
  ds_read_b64_tr_b16 v[148:149], v23 offset:16384
  ds_read_b64_tr_b16 v[150:151], v23 offset:16640
  ds_read_b64_tr_b16 v[152:153], v23 offset:18432
  ds_read_b64_tr_b16 v[154:155], v23 offset:18688
  ds_read_b64_tr_b16 v[156:157], v23 offset:20480
  ds_read_b64_tr_b16 v[158:159], v23 offset:20736
  ds_read_b64_tr_b16 v[160:161], v23 offset:22528
  ds_read_b64_tr_b16 v[162:163], v23 offset:22784
  ds_read_b64_tr_b16 v[164:165], v23 offset:24576
  ds_read_b64_tr_b16 v[166:167], v23 offset:24832
  ds_read_b64_tr_b16 v[168:169], v23 offset:26624
  ds_read_b64_tr_b16 v[170:171], v23 offset:26880
  ds_read_b64_tr_b16 v[172:173], v23 offset:32
  ds_read_b64_tr_b16 v[174:175], v23 offset:288
  ds_read_b64_tr_b16 v[176:177], v23 offset:2080
  ds_read_b64_tr_b16 v[178:179], v23 offset:2336
  ds_read_b64_tr_b16 v[180:181], v23 offset:4128
  ds_read_b64_tr_b16 v[182:183], v23 offset:4384
  ds_read_b64_tr_b16 v[184:185], v23 offset:6176
  ds_read_b64_tr_b16 v[186:187], v23 offset:6432
  ds_read_b64_tr_b16 v[188:189], v23 offset:8224
  ds_read_b64_tr_b16 v[190:191], v23 offset:8480
  ds_read_b64_tr_b16 v[192:193], v23 offset:10272
  ds_read_b64_tr_b16 v[194:195], v23 offset:10528
  ds_read_b64_tr_b16 v[196:197], v23 offset:12320
  ds_read_b64_tr_b16 v[198:199], v23 offset:12576
  ds_read_b64_tr_b16 v[200:201], v23 offset:14368
  ds_read_b64_tr_b16 v[202:203], v23 offset:14624
  ds_read_b64_tr_b16 v[204:205], v23 offset:16416
  ds_read_b64_tr_b16 v[206:207], v23 offset:16672
  ds_read_b64_tr_b16 v[208:209], v23 offset:18464
  ds_read_b64_tr_b16 v[210:211], v23 offset:18720
  ds_read_b64_tr_b16 v[212:213], v23 offset:20512
  ds_read_b64_tr_b16 v[214:215], v23 offset:20768
  ds_read_b64_tr_b16 v[216:217], v23 offset:22560
  ds_read_b64_tr_b16 v[218:219], v23 offset:22816
  ds_read_b64_tr_b16 v[220:221], v23 offset:24608
  ds_read_b64_tr_b16 v[222:223], v23 offset:24864
  ds_read_b64_tr_b16 v[224:225], v23 offset:26656
  ds_read_b64_tr_b16 v[226:227], v23 offset:26912
  v_lshlrev_b32 v25, 16, v24
  v_bfe_u32 v26, v22, 2, 1
  v_lshl_add_u32 v25, v26, 6, v25
  v_lshl_add_u32 v25, v21, 4, v25
  s_lshl_b32 s43, s4, 5
  s_add_u32 s43, s43, s70
  s_lshl_b32 s43, s43, 13
  s_add_u32 s43, s43, 65536
  s_lshl_b32 s44, s7, 7
  s_add_u32 s43, s43, s44
  s_mov_b32 s48, 0xf0f0f0f0
  s_mov_b32 s49, 0xf0f0f0f0
  s_waitcnt lgkmcnt(0)
  s_mul_i32 s22, s23, 0x9E3779B1
  s_add_u32 s22, s22, 0x7F4A7C15
  v_mov_b32 v29, s22
  v_mov_b32 v31, s22
  s_waitcnt vmcnt(0) lgkmcnt(0)
  v_mfma_f32_16x16x32_bf16 v[36:39], v[116:119], v[60:63], 0
  v_mfma_f32_16x16x32_bf16 v[40:43], v[172:175], v[60:63], 0
  v_mfma_f32_16x16x32_bf16 v[36:39], v[120:123], v[64:67], v[36:39]
  v_mfma_f32_16x16x32_bf16 v[40:43], v[176:179], v[64:67], v[40:43]
  v_mfma_f32_16x16x32_bf16 v[36:39], v[124:127], v[68:71], v[36:39]
  v_mfma_f32_16x16x32_bf16 v[40:43], v[180:183], v[68:71], v[40:43]
  v_mfma_f32_16x16x32_bf16 v[36:39], v[128:131], v[72:75], v[36:39]
  v_mfma_f32_16x16x32_bf16 v[40:43], v[184:187], v[72:75], v[40:43]
  v_mfma_f32_16x16x32_bf16 v[36:39], v[132:135], v[76:79], v[36:39]
  v_mfma_f32_16x16x32_bf16 v[40:43], v[188:191], v[76:79], v[40:43]
  v_mfma_f32_16x16x32_bf16 v[36:39], v[136:139], v[80:83], v[36:39]
  v_mfma_f32_16x16x32_bf16 v[40:43], v[192:195], v[80:83], v[40:43]
  v_mfma_f32_16x16x32_bf16 v[36:39], v[140:143], v[84:87], v[36:39]
  v_mfma_f32_16x16x32_bf16 v[40:43], v[196:199], v[84:87], v[40:43]
  v_mfma_f32_16x16x32_bf16 v[36:39], v[144:147], v[88:91], v[36:39]
  v_mfma_f32_16x16x32_bf16 v[40:43], v[200:203], v[88:91], v[40:43]
  v_mfma_f32_16x16x32_bf16 v[36:39], v[148:151], v[92:95], v[36:39]
  v_mfma_f32_16x16x32_bf16 v[40:43], v[204:207], v[92:95], v[40:43]
  v_mfma_f32_16x16x32_bf16 v[36:39], v[152:155], v[96:99], v[36:39]
  v_mfma_f32_16x16x32_bf16 v[40:43], v[208:211], v[96:99], v[40:43]
  v_mfma_f32_16x16x32_bf16 v[36:39], v[156:159], v[100:103], v[36:39]
  v_mfma_f32_16x16x32_bf16 v[40:43], v[212:215], v[100:103], v[40:43]
  v_mfma_f32_16x16x32_bf16 v[36:39], v[160:163], v[104:107], v[36:39]
  v_mfma_f32_16x16x32_bf16 v[40:43], v[216:219], v[104:107], v[40:43]
  v_mfma_f32_16x16x32_bf16 v[36:39], v[164:167], v[108:111], v[36:39]
  v_mfma_f32_16x16x32_bf16 v[40:43], v[220:223], v[108:111], v[40:43]
  v_mfma_f32_16x16x32_bf16 v[36:39], v[168:171], v[112:115], v[36:39]
  v_mfma_f32_16x16x32_bf16 v[40:43], v[224:227], v[112:115], v[40:43]
  s_nop 7
  v_cvt_pk_bf16_f32 v32, v36, v37
  v_cvt_pk_bf16_f32 v33, v38, v39
  v_cvt_pk_bf16_f32 v34, v40, v41
  v_cvt_pk_bf16_f32 v35, v42, v43
  v_cndmask_b32 v28, v32, v34, s[48:49]
  v_cndmask_b32 v30, v33, v35, s[48:49]
  s_mov_b64 s[72:73], exec
  s_mov_b32 exec_lo, 0x00ff00ff
  s_mov_b32 exec_hi, 0x00ff00ff
  buffer_store_dwordx4 v[28:31], v25, s[36:39], s43 offen sc1
  s_mov_b64 exec, s[72:73]
  v_lshlrev_b32 v20, 5, v1
  s_lshl_b32 s43, s68, 13
  s_add_u32 s43, s43, 65536
  s_sleep 40
  s_mov_b32 s67, 0
Lqr_concat_heads__gqa_block_cached__gqa_block_cached__decode_kernel_6:
  buffer_load_dwordx4 v[92:95], v20, s[36:39], s43 offen sc1
  buffer_load_dwordx4 v[96:99], v20, s[36:39], s43 offen offset:16 sc1
  s_waitcnt vmcnt(0)
  v_xor_b32 v21, s22, v93
  v_xor_b32 v22, s22, v95
  v_or_b32 v21, v21, v22
  v_xor_b32 v22, s22, v97
  v_or_b32 v21, v21, v22
  v_xor_b32 v22, s22, v99
  v_or_b32 v21, v21, v22
  v_cmp_ne_u32 vcc, 0, v21
  s_add_u32 s67, s67, 1
  s_cmp_gt_u32 s67, 400000
  s_cbranch_scc1 Lqr_concat_heads__gqa_block_cached__gqa_block_cached__decode_kernel_6_x
  s_cbranch_vccz Lqr_concat_heads__gqa_block_cached__gqa_block_cached__decode_kernel_6_x
  s_sleep 2
  s_branch Lqr_concat_heads__gqa_block_cached__gqa_block_cached__decode_kernel_6
Lqr_concat_heads__gqa_block_cached__gqa_block_cached__decode_kernel_6_x:
  v_mov_b32 v24, v92
  v_mov_b32 v25, v94
  v_mov_b32 v26, v96
  v_mov_b32 v27, v98
  v_lshlrev_b32 v20, 4, v1
  v_add_u32 v20, 159744, v20
  ds_write_b128 v20, v[24:27]
  s_waitcnt lgkmcnt(0)
  v_mov_b32 v20, 160912
  v_mov_b32 v21, 1
  ds_write_b32 v20, v21
  s_mov_b32 s32, s16
  s_mov_b32 s33, s17
  s_mov_b32 s34, 3670016
  s_mov_b32 s35, 0x20000
  v_lshlrev_b32 v20, 4, v1
  s_lshl_b32 s43, s70, 9
  s_lshl_b32 s44, s7, 5
  s_add_u32 s43, s43, s44
  s_mul_i32 s43, s43, 896
  s_mov_b32 s44, 131072
  s_mov_b32 m0, s44
  s_add_u32 s44, s44, 1024
  buffer_load_dwordx4 v20, s[32:35], s43 offen nt lds
  s_add_u32 s43, s43, 1024
  s_mov_b32 m0, s44
  s_add_u32 s44, s44, 1024
  buffer_load_dwordx4 v20, s[32:35], s43 offen nt lds
  s_add_u32 s43, s43, 1024
  s_mov_b32 m0, s44
  s_add_u32 s44, s44, 1024
  buffer_load_dwordx4 v20, s[32:35], s43 offen nt lds
  s_add_u32 s43, s43, 1024
  s_mov_b32 m0, s44
  s_add_u32 s44, s44, 1024
  buffer_load_dwordx4 v20, s[32:35], s43 offen nt lds
  s_add_u32 s43, s43, 1024
  s_mov_b32 m0, s44
  s_add_u32 s44, s44, 1024
  buffer_load_dwordx4 v20, s[32:35], s43 offen nt lds
  s_add_u32 s43, s43, 1024
  s_mov_b32 m0, s44
  s_add_u32 s44, s44, 1024
  buffer_load_dwordx4 v20, s[32:35], s43 offen nt lds
  s_add_u32 s43, s43, 1024
  s_mov_b32 m0, s44
  s_add_u32 s44, s44, 1024
  buffer_load_dwordx4 v20, s[32:35], s43 offen nt lds
  s_add_u32 s43, s43, 1024
  s_mov_b32 m0, s44
  s_add_u32 s44, s44, 1024
  buffer_load_dwordx4 v20, s[32:35], s43 offen nt lds
  s_add_u32 s43, s43, 1024
  s_mov_b32 m0, s44
  s_add_u32 s44, s44, 1024
  buffer_load_dwordx4 v20, s[32:35], s43 offen nt lds
  s_add_u32 s43, s43, 1024
  s_mov_b32 m0, s44
  s_add_u32 s44, s44, 1024
  buffer_load_dwordx4 v20, s[32:35], s43 offen nt lds
  s_add_u32 s43, s43, 1024
  s_mov_b32 m0, s44
  s_add_u32 s44, s44, 1024
  buffer_load_dwordx4 v20, s[32:35], s43 offen nt lds
  s_add_u32 s43, s43, 1024
  s_mov_b32 m0, s44
  s_add_u32 s44, s44, 1024
  buffer_load_dwordx4 v20, s[32:35], s43 offen nt lds
  s_add_u32 s43, s43, 1024
  s_mov_b32 m0, s44
  s_add_u32 s44, s44, 1024
  buffer_load_dwordx4 v20, s[32:35], s43 offen nt lds
  s_add_u32 s43, s43, 1024
  s_mov_b32 m0, s44
  s_add_u32 s44, s44, 1024
  buffer_load_dwordx4 v20, s[32:35], s43 offen nt lds
  s_add_u32 s43, s43, 1024
  s_mov_b32 m0, s44
  s_add_u32 s44, s44, 1024
  buffer_load_dwordx4 v20, s[32:35], s43 offen nt lds
  s_add_u32 s43, s43, 1024
  s_mov_b32 m0, s44
  s_add_u32 s44, s44, 1024
  buffer_load_dwordx4 v20, s[32:35], s43 offen nt lds
  s_add_u32 s43, s43, 1024
  s_mov_b32 m0, s44
  s_add_u32 s44, s44, 1024
  buffer_load_dwordx4 v20, s[32:35], s43 offen nt lds
  s_add_u32 s43, s43, 1024
  s_mov_b32 m0, s44
  s_add_u32 s44, s44, 1024
  buffer_load_dwordx4 v20, s[32:35], s43 offen nt lds
  s_add_u32 s43, s43, 1024
  s_mov_b32 m0, s44
  s_add_u32 s44, s44, 1024
  buffer_load_dwordx4 v20, s[32:35], s43 offen nt lds
  s_add_u32 s43, s43, 1024
  s_mov_b32 m0, s44
  s_add_u32 s44, s44, 1024
  buffer_load_dwordx4 v20, s[32:35], s43 offen nt lds
  s_add_u32 s43, s43, 1024
  s_mov_b32 m0, s44
  s_add_u32 s44, s44, 1024
  buffer_load_dwordx4 v20, s[32:35], s43 offen nt lds
  s_add_u32 s43, s43, 1024
  s_mov_b32 m0, s44
  s_add_u32 s44, s44, 1024
  buffer_load_dwordx4 v20, s[32:35], s43 offen nt lds
  s_add_u32 s43, s43, 1024
  s_mov_b32 m0, s44
  s_add_u32 s44, s44, 1024
  buffer_load_dwordx4 v20, s[32:35], s43 offen nt lds
  s_add_u32 s43, s43, 1024
  s_mov_b32 m0, s44
  s_add_u32 s44, s44, 1024
  buffer_load_dwordx4 v20, s[32:35], s43 offen nt lds
  s_add_u32 s43, s43, 1024
  s_mov_b32 m0, s44
  s_add_u32 s44, s44, 1024
  buffer_load_dwordx4 v20, s[32:35], s43 offen nt lds
  s_add_u32 s43, s43, 1024
  s_mov_b32 m0, s44
  s_add_u32 s44, s44, 1024
  buffer_load_dwordx4 v20, s[32:35], s43 offen nt lds
  s_add_u32 s43, s43, 1024
  s_mov_b32 m0, s44
  s_add_u32 s44, s44, 1024
  buffer_load_dwordx4 v20, s[32:35], s43 offen nt lds
  s_add_u32 s43, s43, 1024
  s_mov_b32 m0, s44
  s_add_u32 s44, s44, 1024
  buffer_load_dwordx4 v20, s[32:35], s43 offen nt lds
  s_add_u32 s43, s43, 1024
  v_mov_b32 v20, 0
  s_lshl_b32 s43, s68, 8
  s_add_u32 s43, s43, 4096
  v_mov_b32 v21, s43
  v_lshlrev_b32 v22, 2, v1
  v_add_u32 v22, 160896, v22
  v_lshlrev_b32 v23, 5, v1
  v_add_u32 v23, 160768, v23
  s_mov_b64 s[74:75], 0xf
  s_mov_b32 s67, 0
L_twl_concat_heads__gqa_block_cached__gqa_block_cached__decode_kernel:
  s_mov_b64 exec, s[74:75]
  s_add_u32 s67, s67, 1
  s_cmp_gt_u32 s67, 1600000
  s_cbranch_scc1 L_twe_concat_heads__gqa_block_cached__gqa_block_cached__decode_kernel
  ds_read_b32 v24, v22
  s_waitcnt lgkmcnt(0)
  v_add_u32 v24, 1, v24
  v_cmp_lt_u32 vcc, v20, v24
  s_nop 1
  s_and_b64 exec, exec, vcc
  s_cbranch_execz L_tws_concat_heads__gqa_block_cached__gqa_block_cached__decode_kernel
  v_mov_b32 v25, 1
  buffer_atomic_add v25, v21, s[36:39], 0 offen sc0 sc1
  s_waitcnt vmcnt(0)
  v_cmp_gt_u32 vcc, 96, v25
  v_mov_b32 v26, 4095
  s_nop 1
  v_cndmask_b32 v26, v26, v25, vcc
  v_and_b32 v27, 7, v20
  v_lshl_add_u32 v27, v27, 2, v23
  v_add_u32 v20, 1, v20
  v_lshl_or_b32 v26, v20, 12, v26
  ds_write_b32 v27, v26
  v_cmp_le_u32 vcc, 96, v25
  s_nop 1
  s_andn2_b64 s[74:75], s[74:75], vcc
  s_cmp_eq_u64 s[74:75], 0
  s_cbranch_scc1 L_twe_concat_heads__gqa_block_cached__gqa_block_cached__decode_kernel
  s_branch L_twl_concat_heads__gqa_block_cached__gqa_block_cached__decode_kernel
L_tws_concat_heads__gqa_block_cached__gqa_block_cached__decode_kernel:
  s_sleep 2
  s_branch L_twl_concat_heads__gqa_block_cached__gqa_block_cached__decode_kernel
L_twe_concat_heads__gqa_block_cached__gqa_block_cached__decode_kernel:
  s_mov_b64 exec, -1
  s_waitcnt vmcnt(0) lgkmcnt(0)
  s_waitcnt vmcnt(0) lgkmcnt(0)
  s_barrier
  v_lshrrev_b32 v20, 4, v1
  v_and_b32 v21, 15, v1
  v_and_b32 v23, 3, v21
  v_lshrrev_b32 v24, 2, v21
  v_lshlrev_b32 v23, 5, v23
  v_add_u32 v23, v23, v24
  v_mul_u32_u24 v23, 4608, v23
  v_mov_b32 v25, v23
  v_lshl_add_u32 v23, v20, 6, v23
  s_lshl_b32 s43, s4, 5
  s_add_u32 s43, s43, s70
  s_mul_i32 s43, s43, 18432
  s_add_u32 s43, s43, 589824
  s_lshl_b32 s44, s7, 8
  s_add_u32 s44, s44, s43
  s_lshr_b32 s45, s7, 3
  s_lshl_b32 s45, s45, 4
  s_add_u32 s45, s45, s43
  s_add_u32 s45, s45, 4096
  s_sleep 30
  s_mov_b32 s67, 0
Lh1_concat_heads__gqa_block_cached__gqa_block_cached__decode_kernel_7:
  buffer_load_dwordx4 v[92:95], v23, s[36:39], s44 offen offset:0 sc1
  buffer_load_dwordx4 v[96:99], v23, s[36:39], s44 offen offset:16 sc1
  buffer_load_dwordx4 v[100:103], v23, s[36:39], s44 offen offset:32 sc1
  buffer_load_dwordx4 v[104:107], v23, s[36:39], s44 offen offset:48 sc1
  buffer_load_dwordx4 v[108:111], v25, s[36:39], s45 offen sc1
  s_waitcnt vmcnt(0)
  v_xor_b32 v26, s22, v93
  v_xor_b32 v27, s22, v95
  v_or_b32 v26, v26, v27
  v_xor_b32 v27, s22, v97
  v_or_b32 v26, v26, v27
  v_xor_b32 v27, s22, v99
  v_or_b32 v26, v26, v27
  v_xor_b32 v27, s22, v101
  v_or_b32 v26, v26, v27
  v_xor_b32 v27, s22, v103
  v_or_b32 v26, v26, v27
  v_xor_b32 v27, s22, v105
  v_or_b32 v26, v26, v27
  v_xor_b32 v27, s22, v107
  v_or_b32 v26, v26, v27
  v_xor_b32 v27, s22, v109
  v_or_b32 v26, v26, v27
  v_xor_b32 v27, s22, v111
  v_or_b32 v26, v26, v27
  v_cmp_ne_u32 vcc, 0, v26
  s_add_u32 s67, s67, 1
  s_cmp_gt_u32 s67, 400000
  s_cbranch_scc1 Lh1_concat_heads__gqa_block_cached__gqa_block_cached__decode_kernel_7_x
  s_cbranch_vccz Lh1_concat_heads__gqa_block_cached__gqa_block_cached__decode_kernel_7_x
  s_sleep 2
  s_branch Lh1_concat_heads__gqa_block_cached__gqa_block_cached__decode_kernel_7
Lh1_concat_heads__gqa_block_cached__gqa_block_cached__decode_kernel_7_x:
  v_mov_b32 v26, v108
  s_nop 1
  v_mov_b32_dpp v27, v26 row_ror:8 row_mask:0xf bank_mask:0xf
  v_max_f32 v26, v26, v27
  s_nop 1
  v_mov_b32_dpp v27, v26 row_ror:4 row_mask:0xf bank_mask:0xf
  v_max_f32 v26, v26, v27
  v_sub_f32 v26, v108, v26
  v_exp_f32 v26, v26
  s_nop 0
  v_mul_f32 v28, v26, v110
  s_nop 1
  v_mov_b32_dpp v27, v28 row_ror:8 row_mask:0xf bank_mask:0xf
  v_add_f32 v28, v28, v27
  s_nop 1
  v_mov_b32_dpp v27, v28 row_ror:4 row_mask:0xf bank_mask:0xf
  v_add_f32 v28, v28, v27
  v_rcp_f32 v28, v28
  s_nop 0
  v_mul_f32 v26, v26, v28
  v_mul_f32 v92, v92, v26
  v_mul_f32 v94, v94, v26
  v_mul_f32 v96, v96, v26
  v_mul_f32 v98, v98, v26
  v_mul_f32 v100, v100, v26
  v_mul_f32 v102, v102, v26
  v_mul_f32 v104, v104, v26
  v_mul_f32 v106, v106, v26
  s_nop 1
  v_mov_b32_dpp v160, v92 row_ror:8 row_mask:0xf bank_mask:0xf
  v_mov_b32_dpp v161, v94 row_ror:8 row_mask:0xf bank_mask:0xf
  v_mov_b32_dpp v162, v96 row_ror:8 row_mask:0xf bank_mask:0xf
  v_mov_b32_dpp v163, v98 row_ror:8 row_mask:0xf bank_mask:0xf
  v_mov_b32_dpp v164, v100 row_ror:8 row_mask:0xf bank_mask:0xf
  v_mov_b32_dpp v165, v102 row_ror:8 row_mask:0xf bank_mask:0xf
  v_mov_b32_dpp v166, v104 row_ror:8 row_mask:0xf bank_mask:0xf
  v_mov_b32_dpp v167, v106 row_ror:8 row_mask:0xf bank_mask:0xf
  v_add_f32 v92, v92, v160
  v_add_f32 v94, v94, v161
  v_add_f32 v96, v96, v162
  v_add_f32 v98, v98, v163
  v_add_f32 v100, v100, v164
  v_add_f32 v102, v102, v165
  v_add_f32 v104, v104, v166
  v_add_f32 v106, v106, v167
  s_nop 1
  v_mov_b32_dpp v160, v92 row_ror:4 row_mask:0xf bank_mask:0xf
  v_mov_b32_dpp v161, v94 row_ror:4 row_mask:0xf bank_mask:0xf
  v_mov_b32_dpp v162, v96 row_ror:4 row_mask:0xf bank_mask:0xf
  v_mov_b32_dpp v163, v98 row_ror:4 row_mask:0xf bank_mask:0xf
  v_mov_b32_dpp v164, v100 row_ror:4 row_mask:0xf bank_mask:0xf
  v_mov_b32_dpp v165, v102 row_ror:4 row_mask:0xf bank_mask:0xf
  v_mov_b32_dpp v166, v104 row_ror:4 row_mask:0xf bank_mask:0xf
  v_mov_b32_dpp v167, v106 row_ror:4 row_mask:0xf bank_mask:0xf
  v_add_f32 v92, v92, v160
  v_add_f32 v94, v94, v161
  v_add_f32 v96, v96, v162
  v_add_f32 v98, v98, v163
  v_add_f32 v100, v100, v164
  v_add_f32 v102, v102, v165
  v_add_f32 v104, v104, v166
  v_add_f32 v106, v106, v167
  v_cvt_pk_bf16_f32 v220, v92, v94
  v_cvt_pk_bf16_f32 v221, v96, v98
  v_cvt_pk_bf16_f32 v222, v100, v102
  v_cvt_pk_bf16_f32 v223, v104, v106
  v_lshlrev_b32 v20, 4, v1
  v_add_u32 v20, 159744, v20
  ds_write_b128 v20, v[220:223]
  s_waitcnt lgkmcnt(0)
  s_barrier
  s_cmp_ge_u32 s71, 112
  s_cbranch_scc1 L_fin_concat_heads__gqa_block_cached__gqa_block_cached__decode_kernel
  v_lshrrev_b32 v20, 3, v1
  v_lshlrev_b32 v20, 9, v20
  v_and_b32 v21, 7, v1
  v_lshl_add_u32 v20, v21, 4, v20
  s_mul_i32 s43, s4, 28
  s_lshr_b32 s44, s71, 2
  s_add_u32 s43, s43, s44
  s_lshl_b32 s43, s43, 16
  s_and_b32 s45, s71, 3
  s_lshl_b32 s45, s45, 7
  s_add_u32 s43, s43, s45
  s_add_u32 s43, s43, 2097152
  s_sleep 45
  s_mov_b32 s67, 0
Lh2_concat_heads__gqa_block_cached__gqa_block_cached__decode_kernel_8:
  s_mov_b32 s97, s43
  buffer_load_dwordx4 v[92:95], v20, s[36:39], s97 offen sc1
  s_add_u32 s97, s97, 4096
  buffer_load_dwordx4 v[96:99], v20, s[36:39], s97 offen sc1
  s_add_u32 s97, s97, 4096
  buffer_load_dwordx4 v[100:103], v20, s[36:39], s97 offen sc1
  s_add_u32 s97, s97, 4096
  buffer_load_dwordx4 v[104:107], v20, s[36:39], s97 offen sc1
  s_add_u32 s97, s97, 4096
  buffer_load_dwordx4 v[108:111], v20, s[36:39], s97 offen sc1
  s_add_u32 s97, s97, 4096
  buffer_load_dwordx4 v[112:115], v20, s[36:39], s97 offen sc1
  s_add_u32 s97, s97, 4096
  buffer_load_dwordx4 v[116:119], v20, s[36:39], s97 offen sc1
  s_add_u32 s97, s97, 4096
  buffer_load_dwordx4 v[120:123], v20, s[36:39], s97 offen sc1
  s_add_u32 s97, s97, 4096
  buffer_load_dwordx4 v[124:127], v20, s[36:39], s97 offen sc1
  s_add_u32 s97, s97, 4096
  buffer_load_dwordx4 v[128:131], v20, s[36:39], s97 offen sc1
  s_add_u32 s97, s97, 4096
  buffer_load_dwordx4 v[132:135], v20, s[36:39], s97 offen sc1
  s_add_u32 s97, s97, 4096
  buffer_load_dwordx4 v[136:139], v20, s[36:39], s97 offen sc1
  s_add_u32 s97, s97, 4096
  buffer_load_dwordx4 v[140:143], v20, s[36:39], s97 offen sc1
  s_add_u32 s97, s97, 4096
  buffer_load_dwordx4 v[144:147], v20, s[36:39], s97 offen sc1
  s_add_u32 s97, s97, 4096
  buffer_load_dwordx4 v[148:151], v20, s[36:39], s97 offen sc1
  s_add_u32 s97, s97, 4096
  buffer_load_dwordx4 v[152:155], v20, s[36:39], s97 offen sc1
  s_add_u32 s97, s97, 4096
  s_waitcnt vmcnt(0)
  v_xor_b32 v22, s22, v93
  v_xor_b32 v23, s22, v95
  v_or_b32 v22, v22, v23
  v_xor_b32 v23, s22, v97
  v_or_b32 v22, v22, v23
  v_xor_b32 v23, s22, v99
  v_or_b32 v22, v22, v23
  v_xor_b32 v23, s22, v101
  v_or_b32 v22, v22, v23
  v_xor_b32 v23, s22, v103
  v_or_b32 v22, v22, v23
  v_xor_b32 v23, s22, v105
  v_or_b32 v22, v22, v23
  v_xor_b32 v23, s22, v107
  v_or_b32 v22, v22, v23
  v_xor_b32 v23, s22, v109
  v_or_b32 v22, v22, v23
  v_xor_b32 v23, s22, v111
  v_or_b32 v22, v22, v23
  v_xor_b32 v23, s22, v113
  v_or_b32 v22, v22, v23
  v_xor_b32 v23, s22, v115
  v_or_b32 v22, v22, v23
  v_xor_b32 v23, s22, v117
  v_or_b32 v22, v22, v23
  v_xor_b32 v23, s22, v119
  v_or_b32 v22, v22, v23
  v_xor_b32 v23, s22, v121
  v_or_b32 v22, v22, v23
  v_xor_b32 v23, s22, v123
  v_or_b32 v22, v22, v23
  v_xor_b32 v23, s22, v125
  v_or_b32 v22, v22, v23
  v_xor_b32 v23, s22, v127
  v_or_b32 v22, v22, v23
  v_xor_b32 v23, s22, v129
  v_or_b32 v22, v22, v23
  v_xor_b32 v23, s22, v131
  v_or_b32 v22, v22, v23
  v_xor_b32 v23, s22, v133
  v_or_b32 v22, v22, v23
  v_xor_b32 v23, s22, v135
  v_or_b32 v22, v22, v23
  v_xor_b32 v23, s22, v137
  v_or_b32 v22, v22, v23
  v_xor_b32 v23, s22, v139
  v_or_b32 v22, v22, v23
  v_xor_b32 v23, s22, v141
  v_or_b32 v22, v22, v23
  v_xor_b32 v23, s22, v143
  v_or_b32 v22, v22, v23
  v_xor_b32 v23, s22, v145
  v_or_b32 v22, v22, v23
  v_xor_b32 v23, s22, v147
  v_or_b32 v22, v22, v23
  v_xor_b32 v23, s22, v149
  v_or_b32 v22, v22, v23
  v_xor_b32 v23, s22, v151
  v_or_b32 v22, v22, v23
  v_xor_b32 v23, s22, v153
  v_or_b32 v22, v22, v23
  v_xor_b32 v23, s22, v155
  v_or_b32 v22, v22, v23
  v_cmp_ne_u32 vcc, 0, v22
  s_add_u32 s67, s67, 1
  s_cmp_gt_u32 s67, 400000
  s_cbranch_scc1 Lh2_concat_heads__gqa_block_cached__gqa_block_cached__decode_kernel_8_x
  s_cbranch_vccz Lh2_concat_heads__gqa_block_cached__gqa_block_cached__decode_kernel_8_x
  s_sleep 2
  s_branch Lh2_concat_heads__gqa_block_cached__gqa_block_cached__decode_kernel_8
Lh2_concat_heads__gqa_block_cached__gqa_block_cached__decode_kernel_8_x:
  v_mov_b32 v24, v92
  v_mov_b32 v25, v94
  v_add_f32 v24, v24, v96
  v_add_f32 v25, v25, v98
  v_add_f32 v24, v24, v100
  v_add_f32 v25, v25, v102
  v_add_f32 v24, v24, v104
  v_add_f32 v25, v25, v106
  v_add_f32 v24, v24, v108
  v_add_f32 v25, v25, v110
  v_add_f32 v24, v24, v112
  v_add_f32 v25, v25, v114
  v_add_f32 v24, v24, v116
  v_add_f32 v25, v25, v118
  v_add_f32 v24, v24, v120
  v_add_f32 v25, v25, v122
  v_add_f32 v24, v24, v124
  v_add_f32 v25, v25, v126
  v_add_f32 v24, v24, v128
  v_add_f32 v25, v25, v130
  v_add_f32 v24, v24, v132
  v_add_f32 v25, v25, v134
  v_add_f32 v24, v24, v136
  v_add_f32 v25, v25, v138
  v_add_f32 v24, v24, v140
  v_add_f32 v25, v25, v142
  v_add_f32 v24, v24, v144
  v_add_f32 v25, v25, v146
  v_add_f32 v24, v24, v148
  v_add_f32 v25, v25, v150
  v_add_f32 v24, v24, v152
  v_add_f32 v25, v25, v154
  s_nop 1
  v_mov_b32_dpp v26, v24 row_ror:8 row_mask:0xf bank_mask:0xf
  v_add_f32 v24, v24, v26
  v_mov_b32 v26, v24
  v_mov_b32 v27, v24
  s_nop 1
  v_permlane16_swap_b32 v26, v27
  s_nop 1
  v_add_f32 v24, v26, v27
  v_mov_b32 v26, v24
  v_mov_b32 v27, v24
  s_nop 1
  v_permlane32_swap_b32 v26, v27
  s_nop 1
  v_add_f32 v24, v26, v27
  s_nop 1
  v_mov_b32_dpp v26, v25 row_ror:8 row_mask:0xf bank_mask:0xf
  v_add_f32 v25, v25, v26
  v_mov_b32 v26, v25
  v_mov_b32 v27, v25
  s_nop 1
  v_permlane16_swap_b32 v26, v27
  s_nop 1
  v_add_f32 v25, v26, v27
  v_mov_b32 v26, v25
  v_mov_b32 v27, v25
  s_nop 1
  v_permlane32_swap_b32 v26, v27
  s_nop 1
  v_add_f32 v25, v26, v27
  v_cvt_pk_bf16_f32 v24, v24, v25
  s_mov_b32 s32, s18
  s_mov_b32 s33, s19
  s_mov_b32 s34, 7168
  s_mov_b32 s35, 0x20000
  v_lshlrev_b32 v26, 2, v21
  s_mul_i32 s43, s4, 448
  s_lshr_b32 s44, s71, 2
  s_lshl_b32 s44, s44, 4
  s_add_u32 s43, s43, s44
  s_lshl_b32 s43, s43, 1
  s_and_b32 s44, s71, 3
  s_mul_i32 s44, s44, 1792
  s_add_u32 s43, s43, s44
  s_mov_b64 exec, 0xff
  buffer_store_dword v24, v26, s[32:35], s43 offen
  s_cmp_lg_u32 s71, 0
  s_cbranch_scc1 L_fin_concat_heads__gqa_block_cached__gqa_block_cached__decode_kernel
  s_add_u32 s43, s23, 1
  v_mov_b32 v28, s43
  s_lshl_b32 s44, s4, 8
  v_mov_b32 v29, s44
  s_mov_b64 exec, 1
  buffer_store_dword v28, v29, s[36:39], 0 offen offset:0
L_fin_concat_heads__gqa_block_cached__gqa_block_cached__decode_kernel:
L_end_concat_heads__gqa_block_cached__gqa_block_cached__decode_kernel:
  s_endpgm
  .section .rodata,"a"
  .p2align 6
  .amdhsa_kernel concat_heads__gqa_block_cached__gqa_block_cached__decode_kernel
  .amdhsa_next_free_vgpr 256
  .amdhsa_next_free_sgpr 102
  .amdhsa_accum_offset 256
  .amdhsa_group_segment_fixed_size 0
  .amdhsa_kernarg_size 104
  .amdhsa_user_sgpr_count 2
  .amdhsa_user_sgpr_kernarg_segment_ptr 1
  .amdhsa_system_sgpr_workgroup_id_x 1
  .end_amdhsa_kernel
```
